```python
import torch

def _softmax(x, axis=-1):
    return torch.softmax(x, dim=axis)
def _gelu(x):
    return torch.nn.functional.gelu(x, approximate="tanh")
def _silu(x):
    return torch.nn.functional.silu(x)
def _sigmoid(x):
    return torch.sigmoid(x)
def _layernorm(x, axis=-1, eps=1e-5):
    m = x.mean(dim=axis, keepdim=True)
    v = x.var(dim=axis, keepdim=True, unbiased=False)
    return (x - m) / torch.sqrt(v + eps)
def _scatter_add(tgt, idx, src, axis=0):
    return tgt.clone().index_add_(axis, idx, src)
def _segment_sum(src, seg, n):
    out = torch.zeros((n,) + src.shape[1:], dtype=src.dtype)
    return out.index_add_(0, seg, src)
def _pad(x, pw):
    flat = tuple(v for pair in reversed(pw) for v in pair)
    return torch.nn.functional.pad(x, flat)

kernel_name = 'gated_mix__ssm_conv_s4__glu_gated_glu__prompt'

def setup_inputs():

    _w = (lambda a: (lambda t: t.to(torch.bfloat16) if t.is_floating_point() else t)(torch.as_tensor(a)))
    def _A_setup():
        B, L, D, N = 1, 2048, 448, 256
        A_re = -(lambda _x: torch.exp(torch.as_tensor(_x)))((lambda *s: torch.randn(*s, dtype=torch.bfloat16) * 6.4)(D, N))
        A_im = torch.pi * (lambda *s: torch.randn(*s, dtype=torch.bfloat16) * 0.1)(D, N)
        B_re = (lambda *s: torch.randn(*s, dtype=torch.bfloat16) * 0.2)(D, N)
        B_im = (lambda *s: torch.randn(*s, dtype=torch.bfloat16) * 0.2)(D, N)
        C_re = (lambda *s: torch.randn(*s, dtype=torch.bfloat16) * 0.2)(D, N)
        C_im = (lambda *s: torch.randn(*s, dtype=torch.bfloat16) * 0.2)(D, N)
        log_dt = (lambda *s: torch.randn(*s, dtype=torch.bfloat16) * 0.1)(D) * 0.5 - 4.0
        Dskip = (lambda *s: torch.randn(*s, dtype=torch.bfloat16) * 0.1)(D)
        return {
            "u": _w((lambda *s: torch.randn(*s, dtype=torch.bfloat16) * 0.05)(B, L, D)),
            "A_re": _w(A_re),
            "A_im": _w(A_im),
            "B_re": _w(B_re),
            "B_im": _w(B_im),
            "C_re": _w(C_re),
            "C_im": _w(C_im),
            "log_dt": _w(log_dt),
            "Dskip": _w(Dskip),
        }
    _A_in = _A_setup()

    def _B_setup():
        B, S, D, F = 1, 2048, 448, 1792
        return {
            "x": _w((lambda *s: torch.randn(*s, dtype=torch.bfloat16) * 0.05)(B, S, D)),
            "w_gate": _w((lambda *s: torch.randn(*s, dtype=torch.bfloat16) * 0.4)(D, F)),
            "w_up": _w((lambda *s: torch.randn(*s, dtype=torch.bfloat16) * 0.05)(D, F)),
            "w_down": _w((lambda *s: torch.randn(*s, dtype=torch.bfloat16) * 0.05)(F, D)),
        }
    _B_in = _B_setup()

    return {
        "A_u": _A_in["u"],
        "A_A_re": _A_in["A_re"],
        "A_A_im": _A_in["A_im"],
        "A_B_re": _A_in["B_re"],
        "A_B_im": _A_in["B_im"],
        "A_C_re": _A_in["C_re"],
        "A_C_im": _A_in["C_im"],
        "A_log_dt": _A_in["log_dt"],
        "A_Dskip": _A_in["Dskip"],
        "B_x": _B_in["x"],
        "B_w_gate": _B_in["w_gate"],
        "B_w_up": _B_in["w_up"],
        "B_w_down": _B_in["w_down"],
        "gate_w": _w((lambda *s: torch.randn(*s, dtype=torch.bfloat16) * 0.05)(448) * 16.0),
    }

def reference(A_u, A_A_re, A_A_im, A_B_re, A_B_im, A_C_re, A_C_im, A_log_dt, A_Dskip, B_x, B_w_gate, B_w_up, B_w_down, gate_w):
    def _A_ref(u, A_re, A_im, B_re, B_im, C_re, C_im, log_dt, Dskip):
        Bsz, L, D = u.shape
        dt = torch.exp(log_dt)[:, None]
        A = A_re + 1j * A_im
        Bc = B_re + 1j * B_im
        Cc = C_re + 1j * C_im
        logdA = dt * A
        dB = dt * Bc
        l = (lambda x, dt: x.to(dt))(torch.arange(L), A_re.dtype)
        P = torch.exp(logdA[:, :, None] * l[None, None, :])
        K = torch.einsum("dn,dnl,dn->dl", Cc, P, dB).real
        L2 = 2 * L
        Kp = _pad(K, ((0, 0), (0, L)))
        up = (lambda x, *d: x.permute(*d))(u, 0, 2, 1)
        up = _pad(up, ((0, 0), (0, 0), (0, L)))
        Kf = (lambda x, axes=(-2,-1): torch.fft.rfft2(x.float(), dim=axes))(Kp[:, None, :], axes=(-2, -1))
        Uf = (lambda x, axes=(-2,-1): torch.fft.rfft2(x.float(), dim=axes))(up[:, :, None, :], axes=(-2, -1))
        Yf = Uf * Kf[None, :, :, :]
        y = (lambda x, s, axes=(-2,-1): torch.fft.irfft2(x, s=s, dim=axes).to(torch.bfloat16))(Yf, (1, L2), axes=(-2, -1))[:, :, 0, :L]
        y = (lambda x, *d: x.permute(*d))(y, 0, 2, 1) + u * Dskip[None, None, :]
        return y

    def _B_ref(x, w_gate, w_up, w_down):
        g = torch.einsum("bsd,df->bsf", x, w_gate)
        u = torch.einsum("bsd,df->bsf", x, w_up)
        h = _sigmoid(g) * u
        return torch.einsum("bsf,fd->bsd", h, w_down)

    x = A_u
    g = _sigmoid((x * gate_w).sum(-1, keepdims=True))
    a = _A_ref(x, A_A_re, A_A_im, A_B_re, A_B_im, A_C_re, A_C_im, A_log_dt, A_Dskip)
    b = _B_ref(x, B_w_gate, B_w_up, B_w_down)
    return g * a + (1 - g) * b
```

```asm
; @launch grid=(256,1,1) block=(512,1,1) lds=163840
.amdgcn_target "amdgcn-amd-amdhsa--gfx950"
.text
.globl gated_mix__ssm_conv_s4__glu_gated_glu__prompt_kernel
.p2align 8
.type gated_mix__ssm_conv_s4__glu_gated_glu__prompt_kernel,@function
gated_mix__ssm_conv_s4__glu_gated_glu__prompt_kernel:
  s_cmp_ge_u32 s2, 256
  s_cbranch_scc1 L_exit
  s_load_dwordx16 s[16:31], s[0:1], 0
  s_load_dwordx16 s[32:47], s[0:1], 64
  s_load_dwordx2 s[48:49], s[0:1], 128
  v_lshrrev_b32 v1, 6, v0
  v_and_b32 v0, 63, v0
  v_readfirstlane_b32 s3, v1
  s_nop 1
  s_cmp_ge_u32 s3, 1
  s_cbranch_scc1 L_nopf0
  s_getpc_b64 s[90:91]
L_pc0:
  s_sub_u32 s90, s90, L_pc0-gated_mix__ssm_conv_s4__glu_gated_glu__prompt_kernel
  s_subb_u32 s91, s91, 0
  s_bfe_u32 s9, s2, 0x20003
  v_lshl_add_u32 v2, v0, 2, s9
  v_lshlrev_b32 v2, 7, v2
  v_min_u32 v2, L_codeend-gated_mix__ssm_conv_s4__glu_gated_glu__prompt_kernel-4, v2
  global_load_dword v47, v2, s[90:91]
L_nopf0:
  s_and_b32 s4, s2, 7
  s_lshr_b32 s5, s2, 3
  s_cmp_ge_u32 s5, 28
  s_cbranch_scc1 L_helper
  s_mul_i32 s86, s4, 28
  s_add_u32 s86, s86, s5
  s_bfe_u32 s88, s3, 0x10001
  s_and_b32 s9, s3, 1
  s_lshr_b32 s10, s3, 2
  s_lshl1_add_u32 s9, s10, s9
  s_lshl1_add_u32 s10, s86, s88
  s_lshl2_add_u32 s9, s10, s9
  s_lshl_b32 s9, s9, 7
  s_lshl_b32 s12, s10, 1
  v_lshl_add_u32 v72, v0, 1, s9
  v_mov_b32 v73, s12
  v_mov_b32 v16, 0
  v_mov_b64 v[128:129], 0
  v_mov_b64 v[130:131], 0
  v_mov_b64 v[132:133], 0
  v_mov_b32 v134, 0
  s_mul_i32 s6, s5, 37
  s_lshr_b32 s6, s6, 8
  s_mul_i32 s9, s6, 7
  s_sub_u32 s7, s5, s9
  s_and_b32 s8, s3, 3
  s_bfe_u32 s9, s4, 0x10001
  s_mul_i32 s9, s9, 28
  s_add_u32 s9, s9, s5
  s_and_b32 s51, s9, 7
  s_lshr_b32 s12, s9, 3
  s_and_b32 s83, s4, 1
  s_lshl3_add_u32 s83, s83, s51
  s_lshr_b32 s84, s4, 2
  s_mul_i32 s84, s84, 7
  s_add_u32 s84, s84, s12
  s_lshl1_add_u32 s9, s12, s51
  s_sub_u32 s10, s9, 7
  s_cselect_b32 s9, s9, s10
  s_sub_u32 s10, s9, 7
  s_cselect_b32 s9, s9, s10
  s_lshl_b32 s9, s9, 2
  s_mov_b32 s76, 0x06543210
  s_mov_b32 s77, 0x00654321
  s_lshr_b64 s[76:77], s[76:77], s9
  s_lshl_b32 s9, s6, 1
  s_sub_u32 s10, s9, 7
  s_cselect_b32 s9, s9, s10
  s_lshl_b32 s9, s9, 2
  s_mov_b32 s90, 0x06543210
  s_mov_b32 s91, 0x00654321
  s_lshr_b64 s[90:91], s[90:91], s9
  s_mov_b32 s82, s90
  s_lshl_b32 s14, s8, 10
  s_lshl_b32 s15, s8, 12
  s_mov_b32 s54, 1835008
  s_mov_b32 s55, 0x20000
  s_mov_b32 s58, 1605632
  s_mov_b32 s59, 0x20000
  s_mov_b64 s[62:63], s[58:59]
  s_mov_b64 s[66:67], s[58:59]
  s_mov_b64 s[74:75], s[54:55]
  s_mov_b32 s70, 16777216
  s_mov_b32 s71, 0x20000
  s_cmp_lt_u32 s3, 4
  s_cselect_b32 s80, 0, 1
  s_waitcnt lgkmcnt(0)
  global_load_short_d16_hi v128, v72, s[18:19]
  global_load_short_d16_hi v129, v72, s[20:21]
  global_load_short_d16_hi v130, v72, s[22:23]
  global_load_short_d16_hi v131, v72, s[24:25]
  global_load_short_d16_hi v132, v72, s[26:27]
  global_load_short_d16_hi v133, v72, s[28:29]
  global_load_short_d16_hi v134, v73, s[30:31]
  s_mov_b64 s[52:53], s[16:17]
  v_lshrrev_b32 v64, 3, v0
  v_and_b32 v65, 7, v0
  v_lshlrev_b32 v6, 4, v0
  s_cmp_eq_u32 s80, 0
  s_cbranch_scc0 L_S1
  v_and_b32 v66, 2, v64
  v_xor_b32 v66, v66, v65
  s_and_b32 s9, s8, 1
  s_lshl_b32 s9, s9, 2
  v_xor_b32 v66, s9, v66
  v_lshlrev_b32 v66, 4, v66
  s_lshl_b32 s9, s8, 3
  v_add_u32 v67, s9, v64
  v_mul_u32_u24 v67, 3584, v67
  s_lshl_b32 s11, s84, 8
  v_add3_u32 v10, v67, v66, s11
  s_mov_b64 s[56:57], s[36:37]
  s_mov_b64 s[60:61], s[38:39]
  s_mov_b64 s[64:65], s[40:41]
  s_mov_b64 s[68:69], s[48:49]
  s_mov_b64 s[72:73], s[44:45]
  s_add_u32 m0, s14, 114688
  s_bfe_u32 s78, s76, 0x40000
  s_mul_i32 s78, s78, 229376
  buffer_load_dwordx4 v10, s[56:59], s78 offen lds
  s_add_u32 m0, s14, 118784
  s_add_u32 s79, s78, 114688
  buffer_load_dwordx4 v10, s[56:59], s79 offen lds
  s_add_u32 m0, s14, 122880
  s_nop 0
  buffer_load_dwordx4 v10, s[60:63], s78 offen lds
  s_add_u32 m0, s14, 126976
  s_nop 0
  buffer_load_dwordx4 v10, s[60:63], s79 offen lds
  s_mul_i32 s89, s3, 8704
  s_add_u32 s9, s89, 45056
  v_and_b32 v67, 31, v0
  v_lshrrev_b32 v68, 5, v0
  v_lshl_add_u32 v68, v68, 4, s9
  v_mov_b32 v69, 272
  v_mad_u32_u24 v36, v67, v69, v68
  v_lshl_add_u32 v38, v0, 4, s9
  v_mov_b32 v160, 0x3f80
  v_and_b32 v70, 7, v0
  v_or_b32 v70, 0x0c0c0c00, v70
  s_mov_b32 exec_lo, 0xff
  s_mov_b32 exec_hi, 0xff
  v_mov_b32 v71, 0x3020100
  v_mov_b32 v67, 0x13121110
  s_mov_b32 exec_lo, 0xff00
  s_mov_b32 exec_hi, 0xff00
  v_mov_b32 v71, 0x9140808
  v_mov_b32 v67, 0xa040809
  s_mov_b32 exec_lo, 0xff0000
  s_mov_b32 exec_hi, 0xff0000
  v_mov_b32 v71, 0xa0b150a
  v_mov_b32 v67, 0xb06050b
  s_mov_b32 exec_lo, 0xff000000
  s_mov_b32 exec_hi, 0xff000000
  v_mov_b32 v71, 0xc070606
  v_mov_b32 v67, 0x17160c0c
  s_mov_b64 exec, -1
  v_perm_b32 v67, v67, v71, v70
  v_mad_u32_u24 v37, v67, v69, v68
  v_mov_b64 v[48:49], 0
  v_mov_b64 v[50:51], 0
  s_nop 1
  v_mfma_f32_32x32x16_bf16 v[64:79], v[48:51], v[48:51], 0
  v_mfma_f32_32x32x16_bf16 v[80:95], v[48:51], v[48:51], 0
  v_mfma_f32_32x32x16_bf16 v[96:111], v[48:51], v[48:51], 0
  v_mfma_f32_32x32x16_bf16 v[112:127], v[48:51], v[48:51], 0
  s_waitcnt vmcnt(4)
L_kchain:
  s_mov_b32 m0, s89
  v_mul_f32 v134, 0x3fb8aa3b, v134
  v_exp_f32 v134, v134
  v_pk_mul_f32 v[158:159], v[132:133], v[130:131] op_sel:[0,0] op_sel_hi:[0,1]
  v_cvt_pk_bf16_f32 v134, v134, v134
  v_pk_fma_f32 v[224:225], v[132:133], v[130:131], v[158:159] op_sel:[1,1,0] op_sel_hi:[1,0,1] neg_lo:[1,0,0]
  v_lshlrev_b32 v134, 16, v134
  v_mul_f32 v150, 0x3fb8aa3b, v134
  v_mul_f32 v151, 0x3e22f983, v134
  v_pk_mul_f32 v[128:129], v[128:129], v[150:151]
  v_pk_mul_f32 v[224:225], v[224:225], v[134:135] op_sel:[0,0] op_sel_hi:[1,0]
  v_mul_f32 v153, 0x41000000, v129
  v_mul_f32 v152, 0x41000000, v128
  v_fract_f32 v153, v153
  v_exp_f32 v152, v152
  v_cos_f32 v142, v153
  v_sin_f32 v143, -v153
  v_fract_f32 v155, v129
  v_pk_mul_f32 v[142:143], v[142:143], v[152:153] op_sel:[0,0] op_sel_hi:[1,0]
  v_exp_f32 v154, v128
  v_cos_f32 v136, v155
  v_sin_f32 v137, v155
  v_pk_mul_f32 v[156:157], v[142:143], v[142:143] op_sel:[0,0] op_sel_hi:[0,1]
  v_pk_mul_f32 v[136:137], v[136:137], v[154:155] op_sel:[0,0] op_sel_hi:[1,0]
  v_pk_fma_f32 v[144:145], v[142:143], v[142:143], v[156:157] op_sel:[1,1,0] op_sel_hi:[1,0,1] neg_lo:[1,0,0]
  ds_write_addtid_b32 v160 offset:45056
  v_cvt_pk_bf16_f32 v161, v142, v143
  v_cvt_pk_bf16_f32 v162, v144, v145
  v_pk_mul_f32 v[150:151], v[142:143], v[144:145] op_sel:[0,0] op_sel_hi:[0,1]
  v_pk_mul_f32 v[152:153], v[144:145], v[144:145] op_sel:[0,0] op_sel_hi:[0,1]
  v_pk_mul_f32 v[154:155], v[136:137], v[136:137] op_sel:[0,0] op_sel_hi:[0,1]
  v_pk_fma_f32 v[148:149], v[142:143], v[144:145], v[150:151] op_sel:[1,1,0] op_sel_hi:[1,0,1] neg_lo:[1,0,0]
  v_pk_fma_f32 v[146:147], v[144:145], v[144:145], v[152:153] op_sel:[1,1,0] op_sel_hi:[1,0,1] neg_lo:[1,0,0]
  v_pk_fma_f32 v[138:139], v[136:137], v[136:137], v[154:155] op_sel:[1,1,0] op_sel_hi:[1,0,1] neg_lo:[1,0,0]
  v_cvt_pk_bf16_f32 v163, v148, v149
  v_cvt_pk_bf16_f32 v164, v146, v147
  v_pk_mul_f32 v[150:151], v[148:149], v[144:145] op_sel:[0,0] op_sel_hi:[0,1]
  v_pk_mul_f32 v[152:153], v[146:147], v[144:145] op_sel:[0,0] op_sel_hi:[0,1]
  v_pk_fma_f32 v[148:149], v[148:149], v[144:145], v[150:151] op_sel:[1,1,0] op_sel_hi:[1,0,1] neg_lo:[1,0,0]
  v_pk_fma_f32 v[146:147], v[146:147], v[144:145], v[152:153] op_sel:[1,1,0] op_sel_hi:[1,0,1] neg_lo:[1,0,0]
  v_cvt_pk_bf16_f32 v165, v148, v149
  v_cvt_pk_bf16_f32 v166, v146, v147
  v_pk_mul_f32 v[150:151], v[148:149], v[144:145] op_sel:[0,0] op_sel_hi:[0,1]
  v_pk_mul_f32 v[152:153], v[146:147], v[144:145] op_sel:[0,0] op_sel_hi:[0,1]
  v_pk_fma_f32 v[148:149], v[148:149], v[144:145], v[150:151] op_sel:[1,1,0] op_sel_hi:[1,0,1] neg_lo:[1,0,0]
  v_pk_fma_f32 v[146:147], v[146:147], v[144:145], v[152:153] op_sel:[1,1,0] op_sel_hi:[1,0,1] neg_lo:[1,0,0]
  v_cvt_pk_bf16_f32 v167, v148, v149
  v_cvt_pk_bf16_f32 v168, v146, v147
  v_pk_mul_f32 v[150:151], v[148:149], v[144:145] op_sel:[0,0] op_sel_hi:[0,1]
  v_pk_mul_f32 v[152:153], v[146:147], v[144:145] op_sel:[0,0] op_sel_hi:[0,1]
  v_pk_fma_f32 v[148:149], v[148:149], v[144:145], v[150:151] op_sel:[1,1,0] op_sel_hi:[1,0,1] neg_lo:[1,0,0]
  v_pk_fma_f32 v[146:147], v[146:147], v[144:145], v[152:153] op_sel:[1,1,0] op_sel_hi:[1,0,1] neg_lo:[1,0,0]
  ds_write_addtid_b32 v161 offset:45328
  ds_write_addtid_b32 v162 offset:45600
  ds_write_addtid_b32 v163 offset:45872
  ds_write_addtid_b32 v164 offset:46144
  ds_write_addtid_b32 v165 offset:46416
  ds_write_addtid_b32 v166 offset:46688
  ds_write_addtid_b32 v167 offset:46960
  ds_write_addtid_b32 v168 offset:47232
  v_cvt_pk_bf16_f32 v169, v148, v149
  v_cvt_pk_bf16_f32 v170, v146, v147
  v_pk_mul_f32 v[150:151], v[148:149], v[144:145] op_sel:[0,0] op_sel_hi:[0,1]
  v_pk_mul_f32 v[152:153], v[146:147], v[144:145] op_sel:[0,0] op_sel_hi:[0,1]
  v_pk_fma_f32 v[148:149], v[148:149], v[144:145], v[150:151] op_sel:[1,1,0] op_sel_hi:[1,0,1] neg_lo:[1,0,0]
  v_pk_fma_f32 v[146:147], v[146:147], v[144:145], v[152:153] op_sel:[1,1,0] op_sel_hi:[1,0,1] neg_lo:[1,0,0]
  v_cvt_pk_bf16_f32 v171, v148, v149
  v_cvt_pk_bf16_f32 v172, v146, v147
  v_pk_mul_f32 v[150:151], v[148:149], v[144:145] op_sel:[0,0] op_sel_hi:[0,1]
  v_pk_mul_f32 v[152:153], v[146:147], v[144:145] op_sel:[0,0] op_sel_hi:[0,1]
  v_pk_fma_f32 v[148:149], v[148:149], v[144:145], v[150:151] op_sel:[1,1,0] op_sel_hi:[1,0,1] neg_lo:[1,0,0]
  v_pk_fma_f32 v[146:147], v[146:147], v[144:145], v[152:153] op_sel:[1,1,0] op_sel_hi:[1,0,1] neg_lo:[1,0,0]
  v_cvt_pk_bf16_f32 v173, v148, v149
  v_cvt_pk_bf16_f32 v174, v146, v147
  v_pk_mul_f32 v[150:151], v[148:149], v[144:145] op_sel:[0,0] op_sel_hi:[0,1]
  v_pk_mul_f32 v[152:153], v[146:147], v[144:145] op_sel:[0,0] op_sel_hi:[0,1]
  v_pk_fma_f32 v[148:149], v[148:149], v[144:145], v[150:151] op_sel:[1,1,0] op_sel_hi:[1,0,1] neg_lo:[1,0,0]
  v_pk_fma_f32 v[146:147], v[146:147], v[144:145], v[152:153] op_sel:[1,1,0] op_sel_hi:[1,0,1] neg_lo:[1,0,0]
  v_cvt_pk_bf16_f32 v175, v148, v149
  v_cvt_pk_bf16_f32 v161, v146, v147
  v_pk_mul_f32 v[150:151], v[148:149], v[144:145] op_sel:[0,0] op_sel_hi:[0,1]
  v_pk_mul_f32 v[152:153], v[146:147], v[144:145] op_sel:[0,0] op_sel_hi:[0,1]
  v_pk_fma_f32 v[148:149], v[148:149], v[144:145], v[150:151] op_sel:[1,1,0] op_sel_hi:[1,0,1] neg_lo:[1,0,0]
  v_pk_fma_f32 v[146:147], v[146:147], v[144:145], v[152:153] op_sel:[1,1,0] op_sel_hi:[1,0,1] neg_lo:[1,0,0]
  ds_write_addtid_b32 v169 offset:47504
  ds_write_addtid_b32 v170 offset:47776
  ds_write_addtid_b32 v171 offset:48048
  ds_write_addtid_b32 v172 offset:48320
  ds_write_addtid_b32 v173 offset:48592
  ds_write_addtid_b32 v174 offset:48864
  ds_write_addtid_b32 v175 offset:49136
  ds_write_addtid_b32 v161 offset:49408
  v_cvt_pk_bf16_f32 v162, v148, v149
  v_cvt_pk_bf16_f32 v163, v146, v147
  v_pk_mul_f32 v[150:151], v[148:149], v[144:145] op_sel:[0,0] op_sel_hi:[0,1]
  v_pk_mul_f32 v[152:153], v[146:147], v[144:145] op_sel:[0,0] op_sel_hi:[0,1]
  v_pk_fma_f32 v[148:149], v[148:149], v[144:145], v[150:151] op_sel:[1,1,0] op_sel_hi:[1,0,1] neg_lo:[1,0,0]
  v_pk_fma_f32 v[146:147], v[146:147], v[144:145], v[152:153] op_sel:[1,1,0] op_sel_hi:[1,0,1] neg_lo:[1,0,0]
  v_cvt_pk_bf16_f32 v164, v148, v149
  v_cvt_pk_bf16_f32 v165, v146, v147
  v_pk_mul_f32 v[150:151], v[148:149], v[144:145] op_sel:[0,0] op_sel_hi:[0,1]
  v_pk_mul_f32 v[152:153], v[146:147], v[144:145] op_sel:[0,0] op_sel_hi:[0,1]
  v_pk_fma_f32 v[148:149], v[148:149], v[144:145], v[150:151] op_sel:[1,1,0] op_sel_hi:[1,0,1] neg_lo:[1,0,0]
  v_pk_fma_f32 v[146:147], v[146:147], v[144:145], v[152:153] op_sel:[1,1,0] op_sel_hi:[1,0,1] neg_lo:[1,0,0]
  v_cvt_pk_bf16_f32 v166, v148, v149
  v_cvt_pk_bf16_f32 v167, v146, v147
  v_pk_mul_f32 v[150:151], v[148:149], v[144:145] op_sel:[0,0] op_sel_hi:[0,1]
  v_pk_mul_f32 v[152:153], v[146:147], v[144:145] op_sel:[0,0] op_sel_hi:[0,1]
  v_pk_fma_f32 v[148:149], v[148:149], v[144:145], v[150:151] op_sel:[1,1,0] op_sel_hi:[1,0,1] neg_lo:[1,0,0]
  v_pk_fma_f32 v[146:147], v[146:147], v[144:145], v[152:153] op_sel:[1,1,0] op_sel_hi:[1,0,1] neg_lo:[1,0,0]
  v_cvt_pk_bf16_f32 v168, v148, v149
  v_cvt_pk_bf16_f32 v169, v146, v147
  v_pk_mul_f32 v[150:151], v[148:149], v[144:145] op_sel:[0,0] op_sel_hi:[0,1]
  v_pk_mul_f32 v[152:153], v[146:147], v[144:145] op_sel:[0,0] op_sel_hi:[0,1]
  v_pk_fma_f32 v[148:149], v[148:149], v[144:145], v[150:151] op_sel:[1,1,0] op_sel_hi:[1,0,1] neg_lo:[1,0,0]
  v_pk_fma_f32 v[146:147], v[146:147], v[144:145], v[152:153] op_sel:[1,1,0] op_sel_hi:[1,0,1] neg_lo:[1,0,0]
  ds_write_addtid_b32 v162 offset:49680
  ds_write_addtid_b32 v163 offset:49952
  ds_write_addtid_b32 v164 offset:50224
  ds_write_addtid_b32 v165 offset:50496
  ds_write_addtid_b32 v166 offset:50768
  ds_write_addtid_b32 v167 offset:51040
  ds_write_addtid_b32 v168 offset:51312
  ds_write_addtid_b32 v169 offset:51584
  v_cvt_pk_bf16_f32 v170, v148, v149
  v_cvt_pk_bf16_f32 v171, v146, v147
  v_pk_mul_f32 v[150:151], v[148:149], v[144:145] op_sel:[0,0] op_sel_hi:[0,1]
  v_pk_mul_f32 v[152:153], v[146:147], v[144:145] op_sel:[0,0] op_sel_hi:[0,1]
  v_pk_fma_f32 v[148:149], v[148:149], v[144:145], v[150:151] op_sel:[1,1,0] op_sel_hi:[1,0,1] neg_lo:[1,0,0]
  v_pk_fma_f32 v[146:147], v[146:147], v[144:145], v[152:153] op_sel:[1,1,0] op_sel_hi:[1,0,1] neg_lo:[1,0,0]
  v_cvt_pk_bf16_f32 v172, v148, v149
  v_cvt_pk_bf16_f32 v173, v146, v147
  v_pk_mul_f32 v[150:151], v[148:149], v[144:145] op_sel:[0,0] op_sel_hi:[0,1]
  v_pk_mul_f32 v[152:153], v[146:147], v[144:145] op_sel:[0,0] op_sel_hi:[0,1]
  v_pk_fma_f32 v[148:149], v[148:149], v[144:145], v[150:151] op_sel:[1,1,0] op_sel_hi:[1,0,1] neg_lo:[1,0,0]
  v_pk_fma_f32 v[146:147], v[146:147], v[144:145], v[152:153] op_sel:[1,1,0] op_sel_hi:[1,0,1] neg_lo:[1,0,0]
  v_cvt_pk_bf16_f32 v174, v148, v149
  v_cvt_pk_bf16_f32 v175, v146, v147
  v_pk_mul_f32 v[150:151], v[148:149], v[144:145] op_sel:[0,0] op_sel_hi:[0,1]
  v_pk_mul_f32 v[152:153], v[146:147], v[144:145] op_sel:[0,0] op_sel_hi:[0,1]
  v_pk_fma_f32 v[148:149], v[148:149], v[144:145], v[150:151] op_sel:[1,1,0] op_sel_hi:[1,0,1] neg_lo:[1,0,0]
  v_pk_fma_f32 v[146:147], v[146:147], v[144:145], v[152:153] op_sel:[1,1,0] op_sel_hi:[1,0,1] neg_lo:[1,0,0]
  v_cvt_pk_bf16_f32 v161, v148, v149
  ds_write_addtid_b32 v170 offset:51856
  ds_write_addtid_b32 v171 offset:52128
  ds_write_addtid_b32 v172 offset:52400
  ds_write_addtid_b32 v173 offset:52672
  ds_write_addtid_b32 v174 offset:52944
  ds_write_addtid_b32 v175 offset:53216
  ds_write_addtid_b32 v161 offset:53488
  ds_read_b128 v[192:195], v36 offset:0
  ds_read_b128 v[196:199], v36 offset:32
  ds_read_b128 v[200:203], v36 offset:64
  ds_read_b128 v[204:207], v36 offset:96
  ds_read_b128 v[208:211], v36 offset:128
  ds_read_b128 v[212:215], v36 offset:160
  ds_read_b128 v[216:219], v36 offset:192
  ds_read_b128 v[220:223], v36 offset:224
  v_pk_mul_f32 v[150:151], v[138:139], v[138:139] op_sel:[0,0] op_sel_hi:[0,1]
  v_pk_fma_f32 v[140:141], v[138:139], v[138:139], v[150:151] op_sel:[1,1,0] op_sel_hi:[1,0,1] neg_lo:[1,0,0]
  v_pk_mul_f32 v[150:151], v[224:225], v[136:137] op_sel:[0,0] op_sel_hi:[0,1]
  v_pk_fma_f32 v[226:227], v[224:225], v[136:137], v[150:151] op_sel:[1,1,0] op_sel_hi:[1,0,1] neg_lo:[1,0,0]
  v_pk_mul_f32 v[150:151], v[224:225], v[138:139] op_sel:[0,0] op_sel_hi:[0,1]
  v_pk_fma_f32 v[228:229], v[224:225], v[138:139], v[150:151] op_sel:[1,1,0] op_sel_hi:[1,0,1] neg_lo:[1,0,0]
  v_pk_mul_f32 v[150:151], v[226:227], v[138:139] op_sel:[0,0] op_sel_hi:[0,1]
  v_pk_fma_f32 v[230:231], v[226:227], v[138:139], v[150:151] op_sel:[1,1,0] op_sel_hi:[1,0,1] neg_lo:[1,0,0]
  v_pk_mul_f32 v[150:151], v[224:225], v[140:141] op_sel:[0,0] op_sel_hi:[0,1]
  v_pk_fma_f32 v[232:233], v[224:225], v[140:141], v[150:151] op_sel:[1,1,0] op_sel_hi:[1,0,1] neg_lo:[1,0,0]
  v_pk_mul_f32 v[150:151], v[226:227], v[140:141] op_sel:[0,0] op_sel_hi:[0,1]
  v_pk_fma_f32 v[234:235], v[226:227], v[140:141], v[150:151] op_sel:[1,1,0] op_sel_hi:[1,0,1] neg_lo:[1,0,0]
  v_pk_mul_f32 v[150:151], v[228:229], v[140:141] op_sel:[0,0] op_sel_hi:[0,1]
  v_pk_fma_f32 v[236:237], v[228:229], v[140:141], v[150:151] op_sel:[1,1,0] op_sel_hi:[1,0,1] neg_lo:[1,0,0]
  v_pk_mul_f32 v[150:151], v[230:231], v[140:141] op_sel:[0,0] op_sel_hi:[0,1]
  v_pk_fma_f32 v[238:239], v[230:231], v[140:141], v[150:151] op_sel:[1,1,0] op_sel_hi:[1,0,1] neg_lo:[1,0,0]
  v_cvt_pk_bf16_f32 v162, v224, v225
  v_cvt_pk_bf16_f32 v163, v228, v229
  v_cvt_pk_bf16_f32 v164, v232, v233
  v_cvt_pk_bf16_f32 v165, v236, v237
  v_pk_mul_f32 v[150:151], v[224:225], v[146:147] op_sel:[0,0] op_sel_hi:[0,1] neg_hi:[0,1]
  v_pk_mul_f32 v[152:153], v[228:229], v[146:147] op_sel:[0,0] op_sel_hi:[0,1] neg_hi:[0,1]
  v_pk_mul_f32 v[154:155], v[232:233], v[146:147] op_sel:[0,0] op_sel_hi:[0,1] neg_hi:[0,1]
  v_pk_mul_f32 v[156:157], v[236:237], v[146:147] op_sel:[0,0] op_sel_hi:[0,1] neg_hi:[0,1]
  v_pk_fma_f32 v[224:225], v[224:225], v[146:147], v[150:151] op_sel:[1,1,0] op_sel_hi:[1,0,1]
  v_pk_fma_f32 v[228:229], v[228:229], v[146:147], v[152:153] op_sel:[1,1,0] op_sel_hi:[1,0,1]
  v_pk_fma_f32 v[232:233], v[232:233], v[146:147], v[154:155] op_sel:[1,1,0] op_sel_hi:[1,0,1]
  v_pk_fma_f32 v[236:237], v[236:237], v[146:147], v[156:157] op_sel:[1,1,0] op_sel_hi:[1,0,1]
  v_cvt_pk_bf16_f32 v166, v226, v227
  v_cvt_pk_bf16_f32 v167, v230, v231
  v_cvt_pk_bf16_f32 v168, v234, v235
  v_cvt_pk_bf16_f32 v169, v238, v239
  v_pk_mul_f32 v[150:151], v[224:225], v[146:147] op_sel:[0,0] op_sel_hi:[0,1] neg_hi:[0,1]
  v_pk_mul_f32 v[152:153], v[232:233], v[146:147] op_sel:[0,0] op_sel_hi:[0,1] neg_hi:[0,1]
  v_pk_fma_f32 v[226:227], v[224:225], v[146:147], v[150:151] op_sel:[1,1,0] op_sel_hi:[1,0,1]
  v_pk_fma_f32 v[230:231], v[232:233], v[146:147], v[152:153] op_sel:[1,1,0] op_sel_hi:[1,0,1]
  ds_write_addtid_b32 v162 offset:45056
  ds_write_addtid_b32 v163 offset:45600
  ds_write_addtid_b32 v164 offset:49408
  ds_write_addtid_b32 v165 offset:49952
  ds_write_addtid_b32 v166 offset:45328
  ds_write_addtid_b32 v167 offset:45872
  ds_write_addtid_b32 v168 offset:49680
  ds_write_addtid_b32 v169 offset:50224
  v_cvt_pk_bf16_f32 v170, v224, v225
  v_cvt_pk_bf16_f32 v171, v228, v229
  v_cvt_pk_bf16_f32 v172, v232, v233
  v_cvt_pk_bf16_f32 v173, v236, v237
  v_pk_mul_f32 v[150:151], v[226:227], v[146:147] op_sel:[0,0] op_sel_hi:[0,1] neg_hi:[0,1]
  v_pk_mul_f32 v[152:153], v[230:231], v[146:147] op_sel:[0,0] op_sel_hi:[0,1] neg_hi:[0,1]
  v_pk_fma_f32 v[224:225], v[226:227], v[146:147], v[150:151] op_sel:[1,1,0] op_sel_hi:[1,0,1]
  v_pk_fma_f32 v[228:229], v[230:231], v[146:147], v[152:153] op_sel:[1,1,0] op_sel_hi:[1,0,1]
  v_cvt_pk_bf16_f32 v174, v226, v227
  v_cvt_pk_bf16_f32 v175, v230, v231
  v_pk_mul_f32 v[150:151], v[224:225], v[146:147] op_sel:[0,0] op_sel_hi:[0,1] neg_hi:[0,1]
  v_pk_fma_f32 v[232:233], v[224:225], v[146:147], v[150:151] op_sel:[1,1,0] op_sel_hi:[1,0,1]
  v_cvt_pk_bf16_f32 v161, v224, v225
  v_cvt_pk_bf16_f32 v162, v228, v229
  v_pk_mul_f32 v[150:151], v[232:233], v[146:147] op_sel:[0,0] op_sel_hi:[0,1] neg_hi:[0,1]
  v_pk_fma_f32 v[234:235], v[232:233], v[146:147], v[150:151] op_sel:[1,1,0] op_sel_hi:[1,0,1]
  ds_write_addtid_b32 v170 offset:47232
  ds_write_addtid_b32 v171 offset:50496
  ds_write_addtid_b32 v172 offset:47504
  ds_write_addtid_b32 v173 offset:46144
  ds_write_addtid_b32 v174 offset:47776
  ds_write_addtid_b32 v175 offset:50768
  ds_write_addtid_b32 v161 offset:48048
  ds_write_addtid_b32 v162 offset:46416
  v_cvt_pk_bf16_f32 v163, v232, v233
  v_pk_mul_f32 v[150:151], v[234:235], v[146:147] op_sel:[0,0] op_sel_hi:[0,1] neg_hi:[0,1]
  v_pk_fma_f32 v[236:237], v[234:235], v[146:147], v[150:151] op_sel:[1,1,0] op_sel_hi:[1,0,1]
  v_cvt_pk_bf16_f32 v164, v234, v235
  v_pk_mul_f32 v[150:151], v[236:237], v[146:147] op_sel:[0,0] op_sel_hi:[0,1] neg_hi:[0,1]
  v_pk_fma_f32 v[238:239], v[236:237], v[146:147], v[150:151] op_sel:[1,1,0] op_sel_hi:[1,0,1]
  v_cvt_pk_bf16_f32 v165, v236, v237
  v_pk_mul_f32 v[150:151], v[238:239], v[146:147] op_sel:[0,0] op_sel_hi:[0,1] neg_hi:[0,1]
  v_pk_fma_f32 v[224:225], v[238:239], v[146:147], v[150:151] op_sel:[1,1,0] op_sel_hi:[1,0,1]
  v_cvt_pk_bf16_f32 v166, v238, v239
  v_cvt_pk_bf16_f32 v167, v224, v225
  ds_write_addtid_b32 v163 offset:46688
  ds_write_addtid_b32 v164 offset:46960
  ds_write_addtid_b32 v165 offset:48320
  ds_write_addtid_b32 v166 offset:51040
  ds_write_addtid_b32 v167 offset:51312
  ds_read_b128 v[224:227], v37 offset:0
  ds_read_b128 v[228:231], v37 offset:32
  ds_read_b128 v[232:235], v37 offset:64
  ds_read_b128 v[236:239], v37 offset:96
  ds_read_b128 v[240:243], v37 offset:128
  ds_read_b128 v[244:247], v37 offset:160
  ds_read_b128 v[248:251], v37 offset:192
  ds_read_b128 v[252:255], v37 offset:224
  s_cmp_eq_u32 s80, 0
  s_cbranch_scc0 L_ktailS
  v_and_b32 v42, 15, v0
  v_lshrrev_b32 v40, 4, v0
  s_and_b32 s9, s8, 1
  s_lshl_b32 s10, s9, 13
  v_lshl_add_u32 v41, v42, 7, s10
  v_bfe_u32 v42, v0, 1, 3
  v_xor_b32 v42, v42, v40
  v_lshl_add_u32 v1, v42, 4, v41
  v_xor_b32 v2, 64, v1
  v_bfe_u32 v41, v0, 2, 2
  v_and_b32 v42, 3, v0
  v_lshlrev_b32 v42, 3, v42
  s_waitcnt lgkmcnt(7)
  v_mfma_f32_32x32x16_bf16 v[176:191], v[224:227], v[192:195], 0
  v_bfe_u32 v43, v0, 3, 2
  v_lshl_add_u32 v42, v43, 5, v42
  v_lshl_add_u32 v42, v41, 7, v42
  v_lshl_add_u32 v43, v40, 10, v42
  s_lshr_b32 s10, s8, 1
  s_waitcnt lgkmcnt(6)
  v_mfma_f32_32x32x16_bf16 v[176:191], v[228:231], v[196:199], v[176:191]
  s_lshl_b32 s12, s10, 6
  v_xor_b32 v8, s12, v43
  v_add_u32 v5, 114688, v8
  v_xor_b32 v4, 32, v5
  s_mov_b32 s94, 7
  s_waitcnt lgkmcnt(5)
  v_mfma_f32_32x32x16_bf16 v[176:191], v[232:235], v[200:203], v[176:191]
  s_mov_b32 s77, 0x7987987
  s_mov_b32 s87, 0xbfb8aa3b
  s_lshl1_add_u32 s9, s83, s9
  s_mul_i32 s9, s9, 14
  s_add_u32 s9, s9, s84
  s_waitcnt lgkmcnt(4)
  v_mfma_f32_32x32x16_bf16 v[176:191], v[236:239], v[204:207], v[176:191]
  s_lshl2_add_u32 s9, s9, s10
  s_lshl_b32 s96, s9, 12
  s_add_u32 s96, s96, 7340032
  s_lshl_b32 s97, s9, 8
  s_add_u32 s97, s97, 327680
  s_waitcnt lgkmcnt(3)
  v_mfma_f32_32x32x16_bf16 v[176:191], v[240:243], v[208:211], v[176:191]
  v_lshrrev_b32 v39, 3, v0
  v_and_b32 v9, 6, v39
  v_xor_b32 v9, v9, v0
  v_and_b32 v9, 7, v9
  v_lshlrev_b32 v9, 4, v9
  s_waitcnt lgkmcnt(2)
  v_mfma_f32_32x32x16_bf16 v[176:191], v[244:247], v[212:215], v[176:191]
  v_mul_u32_u24 v39, 896, v39
  s_lshr_b32 s9, s8, 1
  s_mul_i32 s9, s9, 28
  s_and_b32 s10, s8, 1
  s_add_u32 s9, s9, s10
  s_waitcnt lgkmcnt(1)
  v_mfma_f32_32x32x16_bf16 v[176:191], v[248:251], v[216:219], v[176:191]
  s_mul_i32 s9, s9, 224
  s_add_u32 s9, s9, s7
  s_lshl_b32 s9, s9, 7
  v_add3_u32 v9, v9, v39, s9
  v_lshlrev_b32 v7, 2, v0
  s_waitcnt lgkmcnt(0)
  v_mfma_f32_32x32x16_bf16 v[176:191], v[252:255], v[220:223], v[176:191]
  v_mov_b32 v11, 0
  v_mov_b32 v13, 42240
  v_mov_b32 v14, 1
  s_nop 8
  ds_write_b128 v38, v[176:179] offset:4096
  ds_write_b128 v38, v[180:183] offset:5120
  ds_write_b128 v38, v[184:187] offset:6144
  ds_write_b128 v38, v[188:191] offset:7168
  s_setprio 2
  s_waitcnt vmcnt(0) lgkmcnt(0)
  s_barrier
  ds_read_b64_tr_b16 v[32:33], v5 offset:0
  ds_read_b64_tr_b16 v[34:35], v5 offset:512
  ds_read_b128 v[48:51], v1 offset:0
  ds_read_b128 v[52:55], v1 offset:2048
  ds_read_b128 v[56:59], v1 offset:4096
  ds_read_b128 v[60:63], v1 offset:6144
  ds_read_b64_tr_b16 v[36:37], v4 offset:0
  ds_read_b64_tr_b16 v[38:39], v4 offset:512
  ds_read_b64_tr_b16 v[40:41], v5 offset:8192
  ds_read_b64_tr_b16 v[42:43], v5 offset:8704
  ds_read_b64_tr_b16 v[44:45], v4 offset:8192
  ds_read_b64_tr_b16 v[46:47], v4 offset:8704
  s_branch L_g1
L_g1:
  s_waitcnt lgkmcnt(0)
  v_mfma_f32_16x16x32_bf16 v[64:67], v[32:35], v[48:51], v[64:67]
  ds_read_b64_tr_b16 v[128:129], v5 offset:4096
  s_lshr_b32 s77, s77, 4
  v_mfma_f32_16x16x32_bf16 v[68:71], v[32:35], v[52:55], v[68:71]
  ds_read_b64_tr_b16 v[130:131], v5 offset:4608
  s_and_b32 s9, s77, 15
  v_mfma_f32_16x16x32_bf16 v[72:75], v[32:35], v[56:59], v[72:75]
  ds_read_b128 v[144:147], v2 offset:0
  s_lshl_b32 s9, s9, 14
  v_mfma_f32_16x16x32_bf16 v[76:79], v[32:35], v[60:63], v[76:79]
  ds_read_b128 v[148:151], v2 offset:2048
  s_sub_u32 s94, s94, 1
  v_mfma_f32_16x16x32_bf16 v[92:95], v[36:39], v[60:63], v[92:95]
  ds_read_b128 v[152:155], v2 offset:4096
  s_cmp_lg_u32 s94, 0
  v_mfma_f32_16x16x32_bf16 v[88:91], v[36:39], v[56:59], v[88:91]
  ds_read_b128 v[156:159], v2 offset:6144
  v_mfma_f32_16x16x32_bf16 v[84:87], v[36:39], v[52:55], v[84:87]
  ds_read_b64_tr_b16 v[132:133], v4 offset:4096
  v_mfma_f32_16x16x32_bf16 v[80:83], v[36:39], v[48:51], v[80:83]
  ds_read_b64_tr_b16 v[134:135], v4 offset:4608
  v_mfma_f32_16x16x32_bf16 v[96:99], v[40:43], v[48:51], v[96:99]
  ds_read_b64_tr_b16 v[136:137], v5 offset:12288
  v_mfma_f32_16x16x32_bf16 v[100:103], v[40:43], v[52:55], v[100:103]
  ds_read_b64_tr_b16 v[138:139], v5 offset:12800
  v_mfma_f32_16x16x32_bf16 v[104:107], v[40:43], v[56:59], v[104:107]
  ds_read_b64_tr_b16 v[140:141], v4 offset:12288
  v_mfma_f32_16x16x32_bf16 v[108:111], v[40:43], v[60:63], v[108:111]
  ds_read_b64_tr_b16 v[142:143], v4 offset:12800
  v_mfma_f32_16x16x32_bf16 v[124:127], v[44:47], v[60:63], v[124:127]
  v_add_u32 v2, 16384, v2
  v_add_u32 v5, s9, v8
  v_mfma_f32_16x16x32_bf16 v[120:123], v[44:47], v[56:59], v[120:123]
  v_xor_b32 v4, 32, v5
  v_add_u32 v1, 16384, v1
  v_mfma_f32_16x16x32_bf16 v[116:119], v[44:47], v[52:55], v[116:119]
  s_cbranch_scc0 L_g1_exit
  v_mfma_f32_16x16x32_bf16 v[112:115], v[44:47], v[48:51], v[112:115]
  s_waitcnt vmcnt(0) lgkmcnt(0)
  s_barrier
  v_mfma_f32_16x16x32_bf16 v[64:67], v[128:131], v[144:147], v[64:67]
  ds_read_b64_tr_b16 v[32:33], v5 offset:0
  v_mfma_f32_16x16x32_bf16 v[68:71], v[128:131], v[148:151], v[68:71]
  ds_read_b64_tr_b16 v[34:35], v5 offset:512
  v_mfma_f32_16x16x32_bf16 v[72:75], v[128:131], v[152:155], v[72:75]
  ds_read_b128 v[48:51], v1 offset:0
  v_mfma_f32_16x16x32_bf16 v[76:79], v[128:131], v[156:159], v[76:79]
  ds_read_b128 v[52:55], v1 offset:2048
  v_mfma_f32_16x16x32_bf16 v[92:95], v[132:135], v[156:159], v[92:95]
  ds_read_b128 v[56:59], v1 offset:4096
  v_mfma_f32_16x16x32_bf16 v[88:91], v[132:135], v[152:155], v[88:91]
  ds_read_b128 v[60:63], v1 offset:6144
  v_mfma_f32_16x16x32_bf16 v[84:87], v[132:135], v[148:151], v[84:87]
  ds_read_b64_tr_b16 v[36:37], v4 offset:0
  v_mfma_f32_16x16x32_bf16 v[80:83], v[132:135], v[144:147], v[80:83]
  ds_read_b64_tr_b16 v[38:39], v4 offset:512
  v_mfma_f32_16x16x32_bf16 v[96:99], v[136:139], v[144:147], v[96:99]
  ds_read_b64_tr_b16 v[40:41], v5 offset:8192
  v_mfma_f32_16x16x32_bf16 v[100:103], v[136:139], v[148:151], v[100:103]
  ds_read_b64_tr_b16 v[42:43], v5 offset:8704
  v_mfma_f32_16x16x32_bf16 v[104:107], v[136:139], v[152:155], v[104:107]
  ds_read_b64_tr_b16 v[44:45], v4 offset:8192
  v_mfma_f32_16x16x32_bf16 v[108:111], v[136:139], v[156:159], v[108:111]
  ds_read_b64_tr_b16 v[46:47], v4 offset:8704
  v_mfma_f32_16x16x32_bf16 v[124:127], v[140:143], v[156:159], v[124:127]
  v_mfma_f32_16x16x32_bf16 v[120:123], v[140:143], v[152:155], v[120:123]
  v_mfma_f32_16x16x32_bf16 v[116:119], v[140:143], v[148:151], v[116:119]
  v_mfma_f32_16x16x32_bf16 v[112:115], v[140:143], v[144:147], v[112:115]
  s_branch L_g1
L_g1_exit:
  v_mfma_f32_16x16x32_bf16 v[112:115], v[44:47], v[48:51], v[112:115]
  s_waitcnt lgkmcnt(0)
  s_cmp_eq_u32 s80, 0
  s_cbranch_scc0 L_S2
  s_barrier
  s_branch L_P2
L_S1:
  v_and_b32 v67, 3, v64
  v_lshrrev_b32 v68, 2, v64
  v_lshl_add_u32 v67, v67, 6, v68
  s_lshr_b32 s9, s83, 1
  s_and_b32 s10, s83, 1
  s_lshl3_add_u32 s9, s9, s10
  s_lshl4_add_u32 s9, s9, s8
  s_lshl_b32 s9, s9, 1
  v_add_u32 v67, s9, v67
  v_mul_u32_u24 v67, 896, v67
  s_and_b32 s10, s8, 1
  s_lshl_b32 s10, s10, 2
  v_lshrrev_b32 v68, 1, v64
  v_xor_b32 v68, v68, v65
  v_xor_b32 v68, s10, v68
  v_lshl_add_u32 v25, v68, 4, v67
  s_add_u32 m0, s14, 0
  s_bfe_u32 s78, s76, 0x40000
  s_lshl_b32 s78, s78, 7
  buffer_load_dwordx4 v25, s[52:55], s78 offen lds
  s_add_u32 m0, s14, 4096
  s_add_u32 s78, s78, 7168
  buffer_load_dwordx4 v25, s[52:55], s78 offen lds
  s_add_u32 m0, s14, 8192
  s_add_u32 s78, s78, 7168
  buffer_load_dwordx4 v25, s[52:55], s78 offen lds
  s_add_u32 m0, s14, 12288
  s_add_u32 s78, s78, 7168
  buffer_load_dwordx4 v25, s[52:55], s78 offen lds
  v_mov_b32 v39, v73
  v_and_b32 v66, 2, v64
  v_xor_b32 v66, v66, v65
  s_and_b32 s9, s8, 1
  s_lshl_b32 s9, s9, 2
  v_xor_b32 v66, s9, v66
  v_lshlrev_b32 v66, 4, v66
  s_lshl_b32 s9, s8, 3
  v_add_u32 v67, s9, v64
  v_mul_u32_u24 v67, 3584, v67
  s_lshl_b32 s11, s84, 8
  v_add3_u32 v10, v67, v66, s11
  s_mul_i32 s89, s3, 8704
  s_add_u32 s9, s89, 45056
  v_and_b32 v67, 31, v0
  v_lshrrev_b32 v68, 5, v0
  v_lshl_add_u32 v68, v68, 4, s9
  v_mov_b32 v69, 272
  v_mad_u32_u24 v36, v67, v69, v68
  v_lshl_add_u32 v38, v0, 4, s9
  v_mov_b32 v160, 0x3f80
  v_and_b32 v70, 7, v0
  v_or_b32 v70, 0x0c0c0c00, v70
  s_mov_b32 exec_lo, 0xff
  s_mov_b32 exec_hi, 0xff
  v_mov_b32 v71, 0x3020100
  v_mov_b32 v67, 0x13121110
  s_mov_b32 exec_lo, 0xff00
  s_mov_b32 exec_hi, 0xff00
  v_mov_b32 v71, 0x9140808
  v_mov_b32 v67, 0xa040809
  s_mov_b32 exec_lo, 0xff0000
  s_mov_b32 exec_hi, 0xff0000
  v_mov_b32 v71, 0xa0b150a
  v_mov_b32 v67, 0xb06050b
  s_mov_b32 exec_lo, 0xff000000
  s_mov_b32 exec_hi, 0xff000000
  v_mov_b32 v71, 0xc070606
  v_mov_b32 v67, 0x17160c0c
  s_mov_b64 exec, -1
  v_perm_b32 v67, v67, v71, v70
  v_mad_u32_u24 v37, v67, v69, v68
  v_mov_b64 v[48:49], 0
  v_mov_b64 v[50:51], 0
  s_nop 1
  v_mfma_f32_32x32x16_bf16 v[64:79], v[48:51], v[48:51], 0
  v_mfma_f32_32x32x16_bf16 v[80:95], v[48:51], v[48:51], 0
  v_mfma_f32_32x32x16_bf16 v[96:111], v[48:51], v[48:51], 0
  v_mfma_f32_32x32x16_bf16 v[112:127], v[48:51], v[48:51], 0
  s_mov_b64 s[56:57], s[36:37]
  s_mov_b64 s[60:61], s[38:39]
  s_mov_b64 s[64:65], s[40:41]
  s_mov_b64 s[68:69], s[48:49]
  s_mov_b64 s[72:73], s[44:45]
  global_load_short_d16_hi v16, v39, s[32:33]
  s_waitcnt vmcnt(5)
  s_branch L_kchain
L_ktailS:
  s_waitcnt lgkmcnt(7)
  v_mfma_f32_32x32x16_bf16 v[176:191], v[224:227], v[192:195], 0
  s_add_u32 m0, s14, 16384
  s_bfe_u32 s78, s76, 0x40004
  s_lshl_b32 s78, s78, 7
  buffer_load_dwordx4 v25, s[52:55], s78 offen lds
  s_waitcnt lgkmcnt(6)
  v_mfma_f32_32x32x16_bf16 v[176:191], v[228:231], v[196:199], v[176:191]
  s_add_u32 m0, s14, 20480
  s_add_u32 s78, s78, 7168
  buffer_load_dwordx4 v25, s[52:55], s78 offen lds
  s_waitcnt lgkmcnt(5)
  v_mfma_f32_32x32x16_bf16 v[176:191], v[232:235], v[200:203], v[176:191]
  s_add_u32 m0, s14, 24576
  s_add_u32 s78, s78, 7168
  buffer_load_dwordx4 v25, s[52:55], s78 offen lds
  s_waitcnt lgkmcnt(4)
  v_mfma_f32_32x32x16_bf16 v[176:191], v[236:239], v[204:207], v[176:191]
  s_add_u32 m0, s14, 28672
  s_add_u32 s78, s78, 7168
  buffer_load_dwordx4 v25, s[52:55], s78 offen lds
  s_waitcnt lgkmcnt(3)
  v_mfma_f32_32x32x16_bf16 v[176:191], v[240:243], v[208:211], v[176:191]
  s_add_u32 m0, s14, 131072
  s_bfe_u32 s78, s76, 0x40004
  s_mul_i32 s78, s78, 229376
  buffer_load_dwordx4 v10, s[56:59], s78 offen lds
  s_waitcnt lgkmcnt(2)
  v_mfma_f32_32x32x16_bf16 v[176:191], v[244:247], v[212:215], v[176:191]
  s_add_u32 m0, s14, 135168
  s_add_u32 s79, s78, 114688
  buffer_load_dwordx4 v10, s[56:59], s79 offen lds
  s_waitcnt lgkmcnt(1)
  v_mfma_f32_32x32x16_bf16 v[176:191], v[248:251], v[216:219], v[176:191]
  s_add_u32 m0, s14, 139264
  s_nop 0
  buffer_load_dwordx4 v10, s[60:63], s78 offen lds
  s_waitcnt lgkmcnt(0)
  v_mfma_f32_32x32x16_bf16 v[176:191], v[252:255], v[220:223], v[176:191]
  s_add_u32 m0, s14, 143360
  s_nop 0
  buffer_load_dwordx4 v10, s[60:63], s79 offen lds
  s_nop 8
  ds_write_b128 v38, v[176:179] offset:4096
  ds_write_b128 v38, v[180:183] offset:5120
  ds_write_b128 v38, v[184:187] offset:6144
  ds_write_b128 v38, v[188:191] offset:7168
  s_mul_i32 s9, s88, 17408
  s_and_b32 s10, s3, 1
  s_lshl_b32 s10, s10, 11
  s_add_u32 s9, s9, s10
  s_add_u32 s9, s9, 49152
  v_add_u32 v40, s9, v6
  s_setprio 3
  s_waitcnt vmcnt(8) lgkmcnt(0)
  s_barrier
  ds_read_b128 v[128:131], v40 offset:0
  ds_read_b128 v[132:135], v40 offset:1024
  ds_read_b128 v[136:139], v40 offset:8704
  ds_read_b128 v[140:143], v40 offset:9728
  ds_read_b128 v[144:147], v40 offset:34816
  ds_read_b128 v[148:151], v40 offset:35840
  ds_read_b128 v[152:155], v40 offset:43520
  ds_read_b128 v[156:159], v40 offset:44544
  s_add_u32 m0, s14, 32768
  s_bfe_u32 s78, s76, 0x40008
  s_lshl_b32 s78, s78, 7
  buffer_load_dwordx4 v25, s[52:55], s78 offen lds
  s_add_u32 m0, s14, 36864
  s_add_u32 s78, s78, 7168
  buffer_load_dwordx4 v25, s[52:55], s78 offen lds
  s_add_u32 m0, s14, 40960
  s_add_u32 s78, s78, 7168
  buffer_load_dwordx4 v25, s[52:55], s78 offen lds
  s_add_u32 m0, s14, 45056
  s_add_u32 s78, s78, 7168
  buffer_load_dwordx4 v25, s[52:55], s78 offen lds
  s_add_u32 m0, s14, 147456
  s_bfe_u32 s78, s76, 0x40008
  s_mul_i32 s78, s78, 229376
  buffer_load_dwordx4 v10, s[56:59], s78 offen lds
  s_add_u32 m0, s14, 151552
  s_add_u32 s79, s78, 114688
  buffer_load_dwordx4 v10, s[56:59], s79 offen lds
  s_add_u32 m0, s14, 155648
  s_nop 0
  buffer_load_dwordx4 v10, s[60:63], s78 offen lds
  s_add_u32 m0, s14, 159744
  s_nop 0
  buffer_load_dwordx4 v10, s[60:63], s79 offen lds
  s_waitcnt vmcnt(8) lgkmcnt(0)
  s_barrier
  s_add_u32 m0, s14, 49152
  s_bfe_u32 s78, s76, 0x4000c
  s_lshl_b32 s78, s78, 7
  buffer_load_dwordx4 v25, s[52:55], s78 offen lds
  s_add_u32 m0, s14, 53248
  s_add_u32 s78, s78, 7168
  buffer_load_dwordx4 v25, s[52:55], s78 offen lds
  s_add_u32 m0, s14, 57344
  s_add_u32 s78, s78, 7168
  buffer_load_dwordx4 v25, s[52:55], s78 offen lds
  s_add_u32 m0, s14, 61440
  s_add_u32 s78, s78, 7168
  buffer_load_dwordx4 v25, s[52:55], s78 offen lds
  s_add_u32 m0, s14, 114688
  s_bfe_u32 s78, s76, 0x4000c
  s_mul_i32 s78, s78, 229376
  buffer_load_dwordx4 v10, s[56:59], s78 offen lds
  s_add_u32 m0, s14, 118784
  s_add_u32 s79, s78, 114688
  buffer_load_dwordx4 v10, s[56:59], s79 offen lds
  s_add_u32 m0, s14, 122880
  s_nop 0
  buffer_load_dwordx4 v10, s[60:63], s78 offen lds
  s_add_u32 m0, s14, 126976
  s_nop 0
  buffer_load_dwordx4 v10, s[60:63], s79 offen lds
  s_waitcnt vmcnt(8) lgkmcnt(0)
  s_barrier
  s_add_u32 m0, s14, 65536
  s_bfe_u32 s78, s76, 0x40010
  s_lshl_b32 s78, s78, 7
  buffer_load_dwordx4 v25, s[52:55], s78 offen lds
  v_lshrrev_b32 v44, 3, v0
  v_and_b32 v9, 6, v44
  v_xor_b32 v9, v9, v0
  s_add_u32 m0, s14, 69632
  s_add_u32 s78, s78, 7168
  buffer_load_dwordx4 v25, s[52:55], s78 offen lds
  v_and_b32 v9, 7, v9
  v_lshlrev_b32 v9, 4, v9
  v_mul_u32_u24 v44, 896, v44
  s_add_u32 m0, s14, 73728
  s_add_u32 s78, s78, 7168
  buffer_load_dwordx4 v25, s[52:55], s78 offen lds
  s_lshr_b32 s9, s8, 1
  s_mul_i32 s9, s9, 28
  s_add_u32 m0, s14, 77824
  s_add_u32 s78, s78, 7168
  buffer_load_dwordx4 v25, s[52:55], s78 offen lds
  s_and_b32 s10, s8, 1
  s_add_u32 s9, s9, s10
  s_mul_i32 s9, s9, 224
  s_add_u32 m0, s14, 131072
  s_bfe_u32 s78, s76, 0x40010
  s_mul_i32 s78, s78, 229376
  buffer_load_dwordx4 v10, s[56:59], s78 offen lds
  s_add_u32 s9, s9, s7
  s_lshl_b32 s9, s9, 7
  s_add_u32 m0, s14, 135168
  s_add_u32 s79, s78, 114688
  buffer_load_dwordx4 v10, s[56:59], s79 offen lds
  v_add3_u32 v9, v9, v44, s9
  v_lshlrev_b32 v7, 2, v0
  v_mov_b32 v11, 0
  s_add_u32 m0, s14, 139264
  s_nop 0
  buffer_load_dwordx4 v10, s[60:63], s78 offen lds
  v_mov_b32 v13, 42240
  v_mov_b32 v14, 1
  v_and_b32 v46, 15, v0
  s_add_u32 m0, s14, 143360
  s_nop 0
  buffer_load_dwordx4 v10, s[60:63], s79 offen lds
  v_lshrrev_b32 v44, 4, v0
  s_and_b32 s9, s8, 1
  s_lshl_b32 s10, s9, 13
  s_waitcnt vmcnt(8) lgkmcnt(0)
  s_barrier
  s_add_u32 m0, s14, 81920
  s_bfe_u32 s78, s76, 0x40014
  s_lshl_b32 s78, s78, 7
  buffer_load_dwordx4 v25, s[52:55], s78 offen lds
  v_lshl_add_u32 v45, v46, 7, s10
  v_bfe_u32 v46, v0, 1, 3
  v_xor_b32 v46, v46, v44
  s_add_u32 m0, s14, 86016
  s_add_u32 s78, s78, 7168
  buffer_load_dwordx4 v25, s[52:55], s78 offen lds
  v_lshl_add_u32 v1, v46, 4, v45
  v_xor_b32 v2, 64, v1
  v_bfe_u32 v45, v0, 2, 2
  s_add_u32 m0, s14, 90112
  s_add_u32 s78, s78, 7168
  buffer_load_dwordx4 v25, s[52:55], s78 offen lds
  v_and_b32 v46, 3, v0
  v_lshlrev_b32 v46, 3, v46
  s_add_u32 m0, s14, 94208
  s_add_u32 s78, s78, 7168
  buffer_load_dwordx4 v25, s[52:55], s78 offen lds
  v_bfe_u32 v47, v0, 3, 2
  v_lshl_add_u32 v46, v47, 5, v46
  v_lshl_add_u32 v46, v45, 7, v46
  s_add_u32 m0, s14, 147456
  s_bfe_u32 s78, s76, 0x40014
  s_mul_i32 s78, s78, 229376
  buffer_load_dwordx4 v10, s[56:59], s78 offen lds
  v_lshl_add_u32 v47, v44, 10, v46
  s_lshr_b32 s10, s8, 1
  s_add_u32 m0, s14, 151552
  s_add_u32 s79, s78, 114688
  buffer_load_dwordx4 v10, s[56:59], s79 offen lds
  s_lshl_b32 s12, s10, 6
  v_xor_b32 v8, s12, v47
  v_add_u32 v5, 131072, v8
  s_add_u32 m0, s14, 155648
  s_nop 0
  buffer_load_dwordx4 v10, s[60:63], s78 offen lds
  v_xor_b32 v4, 32, v5
  v_lshl_add_u32 v17, v44, 9, v46
  s_mov_b32 s94, 7
  s_add_u32 m0, s14, 159744
  s_nop 0
  buffer_load_dwordx4 v10, s[60:63], s79 offen lds
  s_mov_b32 s77, 0x8798798
  s_mov_b32 s87, 0xbfb8aa3b
  s_lshl1_add_u32 s9, s83, s9
  s_waitcnt vmcnt(8) lgkmcnt(0)
  s_barrier
  s_add_u32 m0, s14, 98304
  s_bfe_u32 s78, s76, 0x40018
  s_lshl_b32 s78, s78, 7
  buffer_load_dwordx4 v25, s[52:55], s78 offen lds
  s_mul_i32 s9, s9, 14
  s_add_u32 s9, s9, s84
  s_lshl2_add_u32 s9, s9, s10
  s_add_u32 m0, s14, 102400
  s_add_u32 s78, s78, 7168
  buffer_load_dwordx4 v25, s[52:55], s78 offen lds
  s_lshl_b32 s96, s9, 12
  s_add_u32 s96, s96, 7348224
  s_lshl_b32 s97, s9, 8
  s_add_u32 m0, s14, 106496
  s_add_u32 s78, s78, 7168
  buffer_load_dwordx4 v25, s[52:55], s78 offen lds
  s_add_u32 s97, s97, 328192
  v_add_u32 v17, s15, v17
  s_add_u32 m0, s14, 110592
  s_add_u32 s78, s78, 7168
  buffer_load_dwordx4 v25, s[52:55], s78 offen lds
  v_xor_b32 v18, 32, v17
  v_xor_b32 v19, 64, v17
  v_xor_b32 v20, 96, v17
  s_add_u32 m0, s14, 114688
  s_bfe_u32 s78, s76, 0x40018
  s_mul_i32 s78, s78, 229376
  buffer_load_dwordx4 v10, s[56:59], s78 offen lds
  s_lshl2_add_u32 s98, s4, s6
  s_mul_i32 s98, s98, 14
  s_add_u32 m0, s14, 118784
  s_add_u32 s79, s78, 114688
  buffer_load_dwordx4 v10, s[56:59], s79 offen lds
  s_lshr_b32 s9, s8, 1
  s_mul_i32 s9, s9, 7
  s_add_u32 s98, s98, s9
  s_add_u32 m0, s14, 122880
  s_nop 0
  buffer_load_dwordx4 v10, s[60:63], s78 offen lds
  s_and_b32 s9, s8, 1
  s_lshl2_add_u32 s98, s98, s9
  v_min_u32 v23, 6, v0
  s_add_u32 m0, s14, 126976
  s_nop 0
  buffer_load_dwordx4 v10, s[60:63], s79 offen lds
  s_lshl_b32 s9, s98, 8
  s_add_u32 s9, s9, 327680
  v_lshl_add_u32 v23, v23, 10, s9
  s_waitcnt vmcnt(8) lgkmcnt(0)
  s_barrier
  s_add_u32 m0, s14, 131072
  s_bfe_u32 s78, s76, 0x40000
  s_mul_i32 s78, s78, 229376
  s_add_u32 s78, s78, 128
  buffer_load_dwordx4 v10, s[56:59], s78 offen lds
  s_lshl_b32 s98, s98, 12
  s_add_u32 s98, s98, 7340032
  v_and_b32 v27, 15, v0
  v_lshlrev_b32 v27, 8, v27
  s_add_u32 s9, s15, 81920
  v_add_u32 v27, s9, v27
  v_lshrrev_b32 v28, 4, v0
  v_and_b32 v29, 7, v0
  v_xor_b32 v28, v28, v29
  v_lshl_add_u32 v27, v28, 4, v27
  s_add_u32 m0, s14, 135168
  s_add_u32 s79, s78, 114688
  buffer_load_dwordx4 v10, s[56:59], s79 offen lds
  v_xor_b32 v28, 64, v27
  v_add_f32 v128, v128, v136
  v_add_f32 v144, v144, v152
  v_add_f32 v129, v129, v137
  v_add_f32 v145, v145, v153
  v_add_f32 v130, v130, v138
  v_add_f32 v146, v146, v154
  v_add_f32 v131, v131, v139
  v_add_f32 v147, v147, v155
  v_add_f32 v132, v132, v140
  s_add_u32 m0, s14, 139264
  s_nop 0
  buffer_load_dwordx4 v10, s[60:63], s78 offen lds
  v_add_f32 v148, v148, v156
  v_add_f32 v133, v133, v141
  v_add_f32 v149, v149, v157
  v_add_f32 v134, v134, v142
  v_add_f32 v150, v150, v158
  v_add_f32 v135, v135, v143
  v_add_f32 v151, v151, v159
  v_add_f32 v128, v128, v144
  v_add_f32 v129, v129, v145
  v_add_f32 v130, v130, v146
  s_add_u32 m0, s14, 143360
  s_nop 0
  buffer_load_dwordx4 v10, s[60:63], s79 offen lds
  v_add_f32 v131, v131, v147
  v_add_f32 v132, v132, v148
  v_add_f32 v133, v133, v149
  v_add_f32 v134, v134, v150
  v_add_f32 v135, v135, v151
  s_bitcmp1_b32 s3, 0
  s_cbranch_scc1 L_pack_hi
  s_mov_b64 exec, 1
  v_add_f32 v128, v16, v128
  s_mov_b64 exec, -1
  v_cvt_pk_bf16_f32 v160, v128, v129
  v_cvt_pk_bf16_f32 v161, v130, v131
  v_cvt_pk_bf16_f32 v162, v132, v132
  v_readlane_b32 s9, v135, 32
  v_mov_b32_dpp v135, v133 wave_shl:1 row_mask:0xc bank_mask:0xf
  s_nop 0
  v_writelane_b32 v135, s9, 63
  v_cvt_pk_bf16_f32 v163, v134, v135
  s_branch L_pack_done
L_pack_hi:
  v_readlane_b32 s9, v130, 0
  v_readlane_b32 s10, v130, 32
  v_mov_b32_dpp v130, v128 wave_shl:1 row_mask:0xf bank_mask:0xf
  v_writelane_b32 v130, s9, 31
  v_writelane_b32 v130, s10, 63
  v_readlane_b32 s9, v134, 0
  v_readlane_b32 s10, v134, 32
  v_mov_b32_dpp v133, v132 wave_shl:1 row_mask:0xf bank_mask:0xf
  v_writelane_b32 v133, s9, 31
  v_writelane_b32 v133, s10, 63
  v_readlane_b32 s9, v135, 0
  v_readlane_b32 s10, v135, 32
  v_mov_b32_dpp v135, v134 wave_shl:1 row_mask:0xf bank_mask:0xf
  v_writelane_b32 v135, s9, 31
  v_writelane_b32 v135, s10, 63
  v_cvt_pk_bf16_f32 v160, v128, v128
  v_cvt_pk_bf16_f32 v161, v128, v129
  v_cvt_pk_bf16_f32 v162, v129, v129
  v_cvt_pk_bf16_f32 v163, v130, v130
  v_cvt_pk_bf16_f32 v164, v132, v132
  v_cvt_pk_bf16_f32 v165, v132, v132
  v_cvt_pk_bf16_f32 v166, v132, v133
  v_cvt_pk_bf16_f32 v167, v133, v133
  v_cvt_pk_bf16_f32 v168, v134, v134
  v_cvt_pk_bf16_f32 v169, v134, v134
  v_cvt_pk_bf16_f32 v170, v134, v135
  v_cvt_pk_bf16_f32 v171, v135, v135
  s_mov_b32 exec_lo, 0xaaaaaaaa
  s_mov_b32 exec_hi, 0xaaaaaaaa
  v_mov_b32 v166, v167
  v_mov_b32 v170, v171
  s_mov_b64 exec, -1
L_pack_done:
  v_and_b32 v40, 31, v0
  v_lshrrev_b32 v41, 5, v0
  s_mul_i32 s9, s88, 4608
  s_add_u32 s9, s9, 42496
  v_lshl_add_u32 v40, v40, 4, s9
  s_bitcmp1_b32 s3, 0
  s_cselect_b32 s10, 9, 3
  v_lshl_add_u32 v172, v41, s10, v40
  v_lshl_add_u32 v173, v41, 10, v40
  s_waitcnt vmcnt(4) lgkmcnt(0)
  s_barrier
  s_add_u32 m0, s14, 147456
  s_bfe_u32 s78, s76, 0x40004
  s_mul_i32 s78, s78, 229376
  s_add_u32 s78, s78, 128
  buffer_load_dwordx4 v10, s[56:59], s78 offen lds
  s_add_u32 m0, s14, 151552
  s_add_u32 s79, s78, 114688
  buffer_load_dwordx4 v10, s[56:59], s79 offen lds
  s_add_u32 m0, s14, 155648
  s_nop 0
  buffer_load_dwordx4 v10, s[60:63], s78 offen lds
  s_add_u32 m0, s14, 159744
  s_nop 0
  buffer_load_dwordx4 v10, s[60:63], s79 offen lds
  global_load_dword v12, v11, s[46:47] sc1
  s_waitcnt vmcnt(5)
  s_setprio 2
  s_barrier
  ds_read_b64_tr_b16 v[32:33], v5 offset:0
  ds_read_b64_tr_b16 v[34:35], v5 offset:512
  ds_read_b128 v[48:51], v1 offset:0
  ds_read_b128 v[52:55], v1 offset:2048
  ds_read_b128 v[56:59], v1 offset:4096
  ds_read_b128 v[60:63], v1 offset:6144
  ds_read_b64_tr_b16 v[36:37], v4 offset:0
  ds_read_b64_tr_b16 v[38:39], v4 offset:512
  ds_read_b64_tr_b16 v[40:41], v5 offset:8192
  ds_read_b64_tr_b16 v[42:43], v5 offset:8704
  ds_read_b64_tr_b16 v[44:45], v4 offset:8192
  ds_read_b64_tr_b16 v[46:47], v4 offset:8704
  s_add_u32 m0, s14, 114688
  s_bfe_u32 s78, s76, 0x40008
  s_mul_i32 s78, s78, 229376
  s_add_u32 s78, s78, 128
  buffer_load_dwordx4 v10, s[56:59], s78 offen lds
  s_add_u32 m0, s14, 118784
  s_add_u32 s79, s78, 114688
  buffer_load_dwordx4 v10, s[56:59], s79 offen lds
  s_waitcnt lgkmcnt(0)
  v_mfma_f32_16x16x32_bf16 v[64:67], v[32:35], v[48:51], v[64:67]
  ds_read_b64_tr_b16 v[128:129], v5 offset:4096
  v_mfma_f32_16x16x32_bf16 v[68:71], v[32:35], v[52:55], v[68:71]
  ds_read_b64_tr_b16 v[130:131], v5 offset:4608
  v_mfma_f32_16x16x32_bf16 v[72:75], v[32:35], v[56:59], v[72:75]
  ds_read_b128 v[144:147], v2 offset:0
  v_mfma_f32_16x16x32_bf16 v[76:79], v[32:35], v[60:63], v[76:79]
  ds_read_b128 v[148:151], v2 offset:2048
  s_add_u32 m0, s14, 122880
  s_nop 0
  buffer_load_dwordx4 v10, s[60:63], s78 offen lds
  v_mfma_f32_16x16x32_bf16 v[92:95], v[36:39], v[60:63], v[92:95]
  ds_read_b128 v[152:155], v2 offset:4096
  v_mfma_f32_16x16x32_bf16 v[88:91], v[36:39], v[56:59], v[88:91]
  ds_read_b128 v[156:159], v2 offset:6144
  v_mfma_f32_16x16x32_bf16 v[84:87], v[36:39], v[52:55], v[84:87]
  ds_read_b64_tr_b16 v[132:133], v4 offset:4096
  v_mfma_f32_16x16x32_bf16 v[80:83], v[36:39], v[48:51], v[80:83]
  ds_read_b64_tr_b16 v[134:135], v4 offset:4608
  v_mfma_f32_16x16x32_bf16 v[96:99], v[40:43], v[48:51], v[96:99]
  ds_read_b64_tr_b16 v[136:137], v5 offset:12288
  s_add_u32 m0, s14, 126976
  s_nop 0
  buffer_load_dwordx4 v10, s[60:63], s79 offen lds
  v_mfma_f32_16x16x32_bf16 v[100:103], v[40:43], v[52:55], v[100:103]
  ds_read_b64_tr_b16 v[138:139], v5 offset:12800
  v_mfma_f32_16x16x32_bf16 v[104:107], v[40:43], v[56:59], v[104:107]
  ds_read_b64_tr_b16 v[140:141], v4 offset:12288
  v_mfma_f32_16x16x32_bf16 v[108:111], v[40:43], v[60:63], v[108:111]
  ds_read_b64_tr_b16 v[142:143], v4 offset:12800
  v_mfma_f32_16x16x32_bf16 v[124:127], v[44:47], v[60:63], v[124:127]
  v_add_u32 v2, 16384, v2
  v_add_u32 v5, 147456, v8
  v_mfma_f32_16x16x32_bf16 v[120:123], v[44:47], v[56:59], v[120:123]
  v_xor_b32 v4, 32, v5
  v_add_u32 v1, 16384, v1
  v_mfma_f32_16x16x32_bf16 v[116:119], v[44:47], v[52:55], v[116:119]
  v_mfma_f32_16x16x32_bf16 v[112:115], v[44:47], v[48:51], v[112:115]
  s_waitcnt vmcnt(4) lgkmcnt(0)
  s_barrier
  v_mfma_f32_16x16x32_bf16 v[64:67], v[128:131], v[144:147], v[64:67]
  ds_read_b64_tr_b16 v[32:33], v5 offset:0
  v_mfma_f32_16x16x32_bf16 v[68:71], v[128:131], v[148:151], v[68:71]
  ds_read_b64_tr_b16 v[34:35], v5 offset:512
  v_mfma_f32_16x16x32_bf16 v[72:75], v[128:131], v[152:155], v[72:75]
  ds_read_b128 v[48:51], v1 offset:0
  v_mfma_f32_16x16x32_bf16 v[76:79], v[128:131], v[156:159], v[76:79]
  ds_read_b128 v[52:55], v1 offset:2048
  v_mfma_f32_16x16x32_bf16 v[92:95], v[132:135], v[156:159], v[92:95]
  ds_read_b128 v[56:59], v1 offset:4096
  v_mfma_f32_16x16x32_bf16 v[88:91], v[132:135], v[152:155], v[88:91]
  ds_read_b128 v[60:63], v1 offset:6144
  v_mfma_f32_16x16x32_bf16 v[84:87], v[132:135], v[148:151], v[84:87]
  ds_read_b64_tr_b16 v[36:37], v4 offset:0
  v_mfma_f32_16x16x32_bf16 v[80:83], v[132:135], v[144:147], v[80:83]
  ds_read_b64_tr_b16 v[38:39], v4 offset:512
  v_mfma_f32_16x16x32_bf16 v[96:99], v[136:139], v[144:147], v[96:99]
  ds_read_b64_tr_b16 v[40:41], v5 offset:8192
  v_mfma_f32_16x16x32_bf16 v[100:103], v[136:139], v[148:151], v[100:103]
  ds_read_b64_tr_b16 v[42:43], v5 offset:8704
  v_mfma_f32_16x16x32_bf16 v[104:107], v[136:139], v[152:155], v[104:107]
  ds_read_b64_tr_b16 v[44:45], v4 offset:8192
  v_mfma_f32_16x16x32_bf16 v[108:111], v[136:139], v[156:159], v[108:111]
  ds_read_b64_tr_b16 v[46:47], v4 offset:8704
  v_mfma_f32_16x16x32_bf16 v[124:127], v[140:143], v[156:159], v[124:127]
  s_add_u32 m0, s14, 131072
  s_bfe_u32 s78, s76, 0x4000c
  s_mul_i32 s78, s78, 229376
  s_add_u32 s78, s78, 128
  buffer_load_dwordx4 v10, s[56:59], s78 offen lds
  v_mfma_f32_16x16x32_bf16 v[120:123], v[140:143], v[152:155], v[120:123]
  v_mfma_f32_16x16x32_bf16 v[116:119], v[140:143], v[148:151], v[116:119]
  s_add_u32 m0, s14, 135168
  s_add_u32 s79, s78, 114688
  buffer_load_dwordx4 v10, s[56:59], s79 offen lds
  v_mfma_f32_16x16x32_bf16 v[112:115], v[140:143], v[144:147], v[112:115]
  s_waitcnt lgkmcnt(0)
  v_mfma_f32_16x16x32_bf16 v[64:67], v[32:35], v[48:51], v[64:67]
  ds_read_b64_tr_b16 v[128:129], v5 offset:4096
  v_mfma_f32_16x16x32_bf16 v[68:71], v[32:35], v[52:55], v[68:71]
  ds_read_b64_tr_b16 v[130:131], v5 offset:4608
  v_mfma_f32_16x16x32_bf16 v[72:75], v[32:35], v[56:59], v[72:75]
  ds_read_b128 v[144:147], v2 offset:0
  v_mfma_f32_16x16x32_bf16 v[76:79], v[32:35], v[60:63], v[76:79]
  ds_read_b128 v[148:151], v2 offset:2048
  s_add_u32 m0, s14, 139264
  s_nop 0
  buffer_load_dwordx4 v10, s[60:63], s78 offen lds
  v_mfma_f32_16x16x32_bf16 v[92:95], v[36:39], v[60:63], v[92:95]
  ds_read_b128 v[152:155], v2 offset:4096
  v_mfma_f32_16x16x32_bf16 v[88:91], v[36:39], v[56:59], v[88:91]
  ds_read_b128 v[156:159], v2 offset:6144
  v_mfma_f32_16x16x32_bf16 v[84:87], v[36:39], v[52:55], v[84:87]
  ds_read_b64_tr_b16 v[132:133], v4 offset:4096
  v_mfma_f32_16x16x32_bf16 v[80:83], v[36:39], v[48:51], v[80:83]
  ds_read_b64_tr_b16 v[134:135], v4 offset:4608
  v_mfma_f32_16x16x32_bf16 v[96:99], v[40:43], v[48:51], v[96:99]
  ds_read_b64_tr_b16 v[136:137], v5 offset:12288
  s_add_u32 m0, s14, 143360
  s_nop 0
  buffer_load_dwordx4 v10, s[60:63], s79 offen lds
  v_mfma_f32_16x16x32_bf16 v[100:103], v[40:43], v[52:55], v[100:103]
  ds_read_b64_tr_b16 v[138:139], v5 offset:12800
  v_mfma_f32_16x16x32_bf16 v[104:107], v[40:43], v[56:59], v[104:107]
  ds_read_b64_tr_b16 v[140:141], v4 offset:12288
  v_mfma_f32_16x16x32_bf16 v[108:111], v[40:43], v[60:63], v[108:111]
  ds_read_b64_tr_b16 v[142:143], v4 offset:12800
  v_mfma_f32_16x16x32_bf16 v[124:127], v[44:47], v[60:63], v[124:127]
  v_add_u32 v2, 16384, v2
  v_add_u32 v5, 114688, v8
  v_mfma_f32_16x16x32_bf16 v[120:123], v[44:47], v[56:59], v[120:123]
  v_xor_b32 v4, 32, v5
  v_add_u32 v1, 16384, v1
  v_mfma_f32_16x16x32_bf16 v[116:119], v[44:47], v[52:55], v[116:119]
  v_mfma_f32_16x16x32_bf16 v[112:115], v[44:47], v[48:51], v[112:115]
  s_waitcnt vmcnt(4) lgkmcnt(0)
  s_barrier
  v_mfma_f32_16x16x32_bf16 v[64:67], v[128:131], v[144:147], v[64:67]
  ds_read_b64_tr_b16 v[32:33], v5 offset:0
  v_mfma_f32_16x16x32_bf16 v[68:71], v[128:131], v[148:151], v[68:71]
  ds_read_b64_tr_b16 v[34:35], v5 offset:512
  v_mfma_f32_16x16x32_bf16 v[72:75], v[128:131], v[152:155], v[72:75]
  ds_read_b128 v[48:51], v1 offset:0
  v_mfma_f32_16x16x32_bf16 v[76:79], v[128:131], v[156:159], v[76:79]
  ds_read_b128 v[52:55], v1 offset:2048
  v_mfma_f32_16x16x32_bf16 v[92:95], v[132:135], v[156:159], v[92:95]
  ds_read_b128 v[56:59], v1 offset:4096
  v_mfma_f32_16x16x32_bf16 v[88:91], v[132:135], v[152:155], v[88:91]
  ds_read_b128 v[60:63], v1 offset:6144
  v_mfma_f32_16x16x32_bf16 v[84:87], v[132:135], v[148:151], v[84:87]
  ds_read_b64_tr_b16 v[36:37], v4 offset:0
  v_mfma_f32_16x16x32_bf16 v[80:83], v[132:135], v[144:147], v[80:83]
  ds_read_b64_tr_b16 v[38:39], v4 offset:512
  v_mfma_f32_16x16x32_bf16 v[96:99], v[136:139], v[144:147], v[96:99]
  ds_read_b64_tr_b16 v[40:41], v5 offset:8192
  v_mfma_f32_16x16x32_bf16 v[100:103], v[136:139], v[148:151], v[100:103]
  ds_read_b64_tr_b16 v[42:43], v5 offset:8704
  v_mfma_f32_16x16x32_bf16 v[104:107], v[136:139], v[152:155], v[104:107]
  ds_read_b64_tr_b16 v[44:45], v4 offset:8192
  v_mfma_f32_16x16x32_bf16 v[108:111], v[136:139], v[156:159], v[108:111]
  ds_read_b64_tr_b16 v[46:47], v4 offset:8704
  v_mfma_f32_16x16x32_bf16 v[124:127], v[140:143], v[156:159], v[124:127]
  s_add_u32 m0, s14, 147456
  s_bfe_u32 s78, s76, 0x40010
  s_mul_i32 s78, s78, 229376
  s_add_u32 s78, s78, 128
  buffer_load_dwordx4 v10, s[56:59], s78 offen lds
  v_mfma_f32_16x16x32_bf16 v[120:123], v[140:143], v[152:155], v[120:123]
  v_mfma_f32_16x16x32_bf16 v[116:119], v[140:143], v[148:151], v[116:119]
  s_add_u32 m0, s14, 151552
  s_add_u32 s79, s78, 114688
  buffer_load_dwordx4 v10, s[56:59], s79 offen lds
  v_mfma_f32_16x16x32_bf16 v[112:115], v[140:143], v[144:147], v[112:115]
  s_waitcnt lgkmcnt(0)
  v_mfma_f32_16x16x32_bf16 v[64:67], v[32:35], v[48:51], v[64:67]
  ds_read_b64_tr_b16 v[128:129], v5 offset:4096
  v_mfma_f32_16x16x32_bf16 v[68:71], v[32:35], v[52:55], v[68:71]
  ds_read_b64_tr_b16 v[130:131], v5 offset:4608
  v_mfma_f32_16x16x32_bf16 v[72:75], v[32:35], v[56:59], v[72:75]
  ds_read_b128 v[144:147], v2 offset:0
  v_mfma_f32_16x16x32_bf16 v[76:79], v[32:35], v[60:63], v[76:79]
  ds_read_b128 v[148:151], v2 offset:2048
  s_add_u32 m0, s14, 155648
  s_nop 0
  buffer_load_dwordx4 v10, s[60:63], s78 offen lds
  v_mfma_f32_16x16x32_bf16 v[92:95], v[36:39], v[60:63], v[92:95]
  ds_read_b128 v[152:155], v2 offset:4096
  v_mfma_f32_16x16x32_bf16 v[88:91], v[36:39], v[56:59], v[88:91]
  ds_read_b128 v[156:159], v2 offset:6144
  v_mfma_f32_16x16x32_bf16 v[84:87], v[36:39], v[52:55], v[84:87]
  ds_read_b64_tr_b16 v[132:133], v4 offset:4096
  v_mfma_f32_16x16x32_bf16 v[80:83], v[36:39], v[48:51], v[80:83]
  ds_read_b64_tr_b16 v[134:135], v4 offset:4608
  v_mfma_f32_16x16x32_bf16 v[96:99], v[40:43], v[48:51], v[96:99]
  ds_read_b64_tr_b16 v[136:137], v5 offset:12288
  s_add_u32 m0, s14, 159744
  s_nop 0
  buffer_load_dwordx4 v10, s[60:63], s79 offen lds
  v_mfma_f32_16x16x32_bf16 v[100:103], v[40:43], v[52:55], v[100:103]
  ds_read_b64_tr_b16 v[138:139], v5 offset:12800
  v_mfma_f32_16x16x32_bf16 v[104:107], v[40:43], v[56:59], v[104:107]
  ds_read_b64_tr_b16 v[140:141], v4 offset:12288
  v_mfma_f32_16x16x32_bf16 v[108:111], v[40:43], v[60:63], v[108:111]
  ds_read_b64_tr_b16 v[142:143], v4 offset:12800
  v_mfma_f32_16x16x32_bf16 v[124:127], v[44:47], v[60:63], v[124:127]
  v_add_u32 v2, 16384, v2
  v_add_u32 v5, 131072, v8
  v_mfma_f32_16x16x32_bf16 v[120:123], v[44:47], v[56:59], v[120:123]
  v_xor_b32 v4, 32, v5
  v_add_u32 v1, 16384, v1
  v_mfma_f32_16x16x32_bf16 v[116:119], v[44:47], v[52:55], v[116:119]
  v_mfma_f32_16x16x32_bf16 v[112:115], v[44:47], v[48:51], v[112:115]
  s_waitcnt vmcnt(4) lgkmcnt(0)
  s_barrier
  v_mfma_f32_16x16x32_bf16 v[64:67], v[128:131], v[144:147], v[64:67]
  ds_read_b64_tr_b16 v[32:33], v5 offset:0
  v_mfma_f32_16x16x32_bf16 v[68:71], v[128:131], v[148:151], v[68:71]
  ds_read_b64_tr_b16 v[34:35], v5 offset:512
  v_mfma_f32_16x16x32_bf16 v[72:75], v[128:131], v[152:155], v[72:75]
  ds_read_b128 v[48:51], v1 offset:0
  v_mfma_f32_16x16x32_bf16 v[76:79], v[128:131], v[156:159], v[76:79]
  ds_read_b128 v[52:55], v1 offset:2048
  v_mfma_f32_16x16x32_bf16 v[92:95], v[132:135], v[156:159], v[92:95]
  ds_read_b128 v[56:59], v1 offset:4096
  v_mfma_f32_16x16x32_bf16 v[88:91], v[132:135], v[152:155], v[88:91]
  ds_read_b128 v[60:63], v1 offset:6144
  v_mfma_f32_16x16x32_bf16 v[84:87], v[132:135], v[148:151], v[84:87]
  ds_read_b64_tr_b16 v[36:37], v4 offset:0
  v_mfma_f32_16x16x32_bf16 v[80:83], v[132:135], v[144:147], v[80:83]
  ds_read_b64_tr_b16 v[38:39], v4 offset:512
  v_mfma_f32_16x16x32_bf16 v[96:99], v[136:139], v[144:147], v[96:99]
  ds_read_b64_tr_b16 v[40:41], v5 offset:8192
  v_mfma_f32_16x16x32_bf16 v[100:103], v[136:139], v[148:151], v[100:103]
  ds_read_b64_tr_b16 v[42:43], v5 offset:8704
  v_mfma_f32_16x16x32_bf16 v[104:107], v[136:139], v[152:155], v[104:107]
  ds_read_b64_tr_b16 v[44:45], v4 offset:8192
  v_mfma_f32_16x16x32_bf16 v[108:111], v[136:139], v[156:159], v[108:111]
  ds_read_b64_tr_b16 v[46:47], v4 offset:8704
  v_mfma_f32_16x16x32_bf16 v[124:127], v[140:143], v[156:159], v[124:127]
  s_add_u32 m0, s14, 114688
  s_bfe_u32 s78, s76, 0x40014
  s_mul_i32 s78, s78, 229376
  s_add_u32 s78, s78, 128
  buffer_load_dwordx4 v10, s[56:59], s78 offen lds
  v_mfma_f32_16x16x32_bf16 v[120:123], v[140:143], v[152:155], v[120:123]
  v_mfma_f32_16x16x32_bf16 v[116:119], v[140:143], v[148:151], v[116:119]
  s_add_u32 m0, s14, 118784
  s_add_u32 s79, s78, 114688
  buffer_load_dwordx4 v10, s[56:59], s79 offen lds
  v_mfma_f32_16x16x32_bf16 v[112:115], v[140:143], v[144:147], v[112:115]
  s_waitcnt lgkmcnt(0)
  v_mfma_f32_16x16x32_bf16 v[64:67], v[32:35], v[48:51], v[64:67]
  ds_read_b64_tr_b16 v[128:129], v5 offset:4096
  v_mfma_f32_16x16x32_bf16 v[68:71], v[32:35], v[52:55], v[68:71]
  ds_read_b64_tr_b16 v[130:131], v5 offset:4608
  v_mfma_f32_16x16x32_bf16 v[72:75], v[32:35], v[56:59], v[72:75]
  ds_read_b128 v[144:147], v2 offset:0
  v_mfma_f32_16x16x32_bf16 v[76:79], v[32:35], v[60:63], v[76:79]
  ds_read_b128 v[148:151], v2 offset:2048
  s_add_u32 m0, s14, 122880
  s_nop 0
  buffer_load_dwordx4 v10, s[60:63], s78 offen lds
  v_mfma_f32_16x16x32_bf16 v[92:95], v[36:39], v[60:63], v[92:95]
  ds_read_b128 v[152:155], v2 offset:4096
  v_mfma_f32_16x16x32_bf16 v[88:91], v[36:39], v[56:59], v[88:91]
  ds_read_b128 v[156:159], v2 offset:6144
  v_mfma_f32_16x16x32_bf16 v[84:87], v[36:39], v[52:55], v[84:87]
  ds_read_b64_tr_b16 v[132:133], v4 offset:4096
  v_mfma_f32_16x16x32_bf16 v[80:83], v[36:39], v[48:51], v[80:83]
  ds_read_b64_tr_b16 v[134:135], v4 offset:4608
  v_mfma_f32_16x16x32_bf16 v[96:99], v[40:43], v[48:51], v[96:99]
  ds_read_b64_tr_b16 v[136:137], v5 offset:12288
  s_add_u32 m0, s14, 126976
  s_nop 0
  buffer_load_dwordx4 v10, s[60:63], s79 offen lds
  v_mfma_f32_16x16x32_bf16 v[100:103], v[40:43], v[52:55], v[100:103]
  ds_read_b64_tr_b16 v[138:139], v5 offset:12800
  v_mfma_f32_16x16x32_bf16 v[104:107], v[40:43], v[56:59], v[104:107]
  ds_read_b64_tr_b16 v[140:141], v4 offset:12288
  v_mfma_f32_16x16x32_bf16 v[108:111], v[40:43], v[60:63], v[108:111]
  ds_read_b64_tr_b16 v[142:143], v4 offset:12800
  v_mfma_f32_16x16x32_bf16 v[124:127], v[44:47], v[60:63], v[124:127]
  v_add_u32 v2, 16384, v2
  v_add_u32 v5, 147456, v8
  v_mfma_f32_16x16x32_bf16 v[120:123], v[44:47], v[56:59], v[120:123]
  v_xor_b32 v4, 32, v5
  v_add_u32 v1, 16384, v1
  v_mfma_f32_16x16x32_bf16 v[116:119], v[44:47], v[52:55], v[116:119]
  v_mfma_f32_16x16x32_bf16 v[112:115], v[44:47], v[48:51], v[112:115]
  s_waitcnt vmcnt(4) lgkmcnt(0)
  s_barrier
  v_mfma_f32_16x16x32_bf16 v[64:67], v[128:131], v[144:147], v[64:67]
  s_bitcmp1_b32 s3, 0
  s_cbranch_scc1 L_kd_hi
  ds_write_b64 v172, v[160:161]
  ds_write_b64 v172, v[162:163] offset:512
  s_branch L_kd_done
L_kd_hi:
  ds_write_b128 v172, v[160:163] offset:1024
  ds_write_b128 v173, v[164:167] offset:2048
  ds_write_b128 v173, v[168:171] offset:2560
L_kd_done:
  ds_read_b64_tr_b16 v[32:33], v5 offset:0
  v_mfma_f32_16x16x32_bf16 v[68:71], v[128:131], v[148:151], v[68:71]
  ds_read_b64_tr_b16 v[34:35], v5 offset:512
  v_mfma_f32_16x16x32_bf16 v[72:75], v[128:131], v[152:155], v[72:75]
  ds_read_b128 v[48:51], v1 offset:0
  v_mfma_f32_16x16x32_bf16 v[76:79], v[128:131], v[156:159], v[76:79]
  ds_read_b128 v[52:55], v1 offset:2048
  v_mfma_f32_16x16x32_bf16 v[92:95], v[132:135], v[156:159], v[92:95]
  ds_read_b128 v[56:59], v1 offset:4096
  v_mfma_f32_16x16x32_bf16 v[88:91], v[132:135], v[152:155], v[88:91]
  ds_read_b128 v[60:63], v1 offset:6144
  v_mfma_f32_16x16x32_bf16 v[84:87], v[132:135], v[148:151], v[84:87]
  ds_read_b64_tr_b16 v[36:37], v4 offset:0
  v_mfma_f32_16x16x32_bf16 v[80:83], v[132:135], v[144:147], v[80:83]
  ds_read_b64_tr_b16 v[38:39], v4 offset:512
  v_mfma_f32_16x16x32_bf16 v[96:99], v[136:139], v[144:147], v[96:99]
  ds_read_b64_tr_b16 v[40:41], v5 offset:8192
  v_mfma_f32_16x16x32_bf16 v[100:103], v[136:139], v[148:151], v[100:103]
  ds_read_b64_tr_b16 v[42:43], v5 offset:8704
  v_mfma_f32_16x16x32_bf16 v[104:107], v[136:139], v[152:155], v[104:107]
  ds_read_b64_tr_b16 v[44:45], v4 offset:8192
  v_mfma_f32_16x16x32_bf16 v[108:111], v[136:139], v[156:159], v[108:111]
  ds_read_b64_tr_b16 v[46:47], v4 offset:8704
  v_mfma_f32_16x16x32_bf16 v[124:127], v[140:143], v[156:159], v[124:127]
  s_add_u32 m0, s14, 131072
  s_bfe_u32 s78, s76, 0x40018
  s_mul_i32 s78, s78, 229376
  s_add_u32 s78, s78, 128
  buffer_load_dwordx4 v10, s[56:59], s78 offen lds
  v_mfma_f32_16x16x32_bf16 v[120:123], v[140:143], v[152:155], v[120:123]
  v_mfma_f32_16x16x32_bf16 v[116:119], v[140:143], v[148:151], v[116:119]
  s_add_u32 m0, s14, 135168
  s_add_u32 s79, s78, 114688
  buffer_load_dwordx4 v10, s[56:59], s79 offen lds
  v_mfma_f32_16x16x32_bf16 v[112:115], v[140:143], v[144:147], v[112:115]
  s_waitcnt lgkmcnt(0)
  v_mfma_f32_16x16x32_bf16 v[64:67], v[32:35], v[48:51], v[64:67]
  ds_read_b64_tr_b16 v[128:129], v5 offset:4096
  v_mfma_f32_16x16x32_bf16 v[68:71], v[32:35], v[52:55], v[68:71]
  ds_read_b64_tr_b16 v[130:131], v5 offset:4608
  v_mfma_f32_16x16x32_bf16 v[72:75], v[32:35], v[56:59], v[72:75]
  ds_read_b128 v[144:147], v2 offset:0
  v_mfma_f32_16x16x32_bf16 v[76:79], v[32:35], v[60:63], v[76:79]
  ds_read_b128 v[148:151], v2 offset:2048
  s_add_u32 m0, s14, 139264
  s_nop 0
  buffer_load_dwordx4 v10, s[60:63], s78 offen lds
  v_mfma_f32_16x16x32_bf16 v[92:95], v[36:39], v[60:63], v[92:95]
  ds_read_b128 v[152:155], v2 offset:4096
  v_mfma_f32_16x16x32_bf16 v[88:91], v[36:39], v[56:59], v[88:91]
  ds_read_b128 v[156:159], v2 offset:6144
  v_mfma_f32_16x16x32_bf16 v[84:87], v[36:39], v[52:55], v[84:87]
  ds_read_b64_tr_b16 v[132:133], v4 offset:4096
  v_mfma_f32_16x16x32_bf16 v[80:83], v[36:39], v[48:51], v[80:83]
  ds_read_b64_tr_b16 v[134:135], v4 offset:4608
  v_mfma_f32_16x16x32_bf16 v[96:99], v[40:43], v[48:51], v[96:99]
  ds_read_b64_tr_b16 v[136:137], v5 offset:12288
  s_add_u32 m0, s14, 143360
  s_nop 0
  buffer_load_dwordx4 v10, s[60:63], s79 offen lds
  v_mfma_f32_16x16x32_bf16 v[100:103], v[40:43], v[52:55], v[100:103]
  ds_read_b64_tr_b16 v[138:139], v5 offset:12800
  v_mfma_f32_16x16x32_bf16 v[104:107], v[40:43], v[56:59], v[104:107]
  ds_read_b64_tr_b16 v[140:141], v4 offset:12288
  v_mfma_f32_16x16x32_bf16 v[108:111], v[40:43], v[60:63], v[108:111]
  ds_read_b64_tr_b16 v[142:143], v4 offset:12800
  v_mfma_f32_16x16x32_bf16 v[124:127], v[44:47], v[60:63], v[124:127]
  v_add_u32 v2, 16384, v2
  v_add_u32 v5, 114688, v8
  v_mfma_f32_16x16x32_bf16 v[120:123], v[44:47], v[56:59], v[120:123]
  v_xor_b32 v4, 32, v5
  v_add_u32 v1, 16384, v1
  v_mfma_f32_16x16x32_bf16 v[116:119], v[44:47], v[52:55], v[116:119]
  v_mfma_f32_16x16x32_bf16 v[112:115], v[44:47], v[48:51], v[112:115]
  s_waitcnt vmcnt(4) lgkmcnt(0)
  s_barrier
  v_mfma_f32_16x16x32_bf16 v[64:67], v[128:131], v[144:147], v[64:67]
  ds_read_b64_tr_b16 v[32:33], v5 offset:0
  v_mfma_f32_16x16x32_bf16 v[68:71], v[128:131], v[148:151], v[68:71]
  ds_read_b64_tr_b16 v[34:35], v5 offset:512
  v_mfma_f32_16x16x32_bf16 v[72:75], v[128:131], v[152:155], v[72:75]
  ds_read_b128 v[48:51], v1 offset:0
  v_mfma_f32_16x16x32_bf16 v[76:79], v[128:131], v[156:159], v[76:79]
  ds_read_b128 v[52:55], v1 offset:2048
  v_mfma_f32_16x16x32_bf16 v[92:95], v[132:135], v[156:159], v[92:95]
  ds_read_b128 v[56:59], v1 offset:4096
  v_mfma_f32_16x16x32_bf16 v[88:91], v[132:135], v[152:155], v[88:91]
  ds_read_b128 v[60:63], v1 offset:6144
  v_mfma_f32_16x16x32_bf16 v[84:87], v[132:135], v[148:151], v[84:87]
  ds_read_b64_tr_b16 v[36:37], v4 offset:0
  v_mfma_f32_16x16x32_bf16 v[80:83], v[132:135], v[144:147], v[80:83]
  ds_read_b64_tr_b16 v[38:39], v4 offset:512
  v_mfma_f32_16x16x32_bf16 v[96:99], v[136:139], v[144:147], v[96:99]
  ds_read_b64_tr_b16 v[40:41], v5 offset:8192
  v_mfma_f32_16x16x32_bf16 v[100:103], v[136:139], v[148:151], v[100:103]
  ds_read_b64_tr_b16 v[42:43], v5 offset:8704
  v_mfma_f32_16x16x32_bf16 v[104:107], v[136:139], v[152:155], v[104:107]
  ds_read_b64_tr_b16 v[44:45], v4 offset:8192
  v_mfma_f32_16x16x32_bf16 v[108:111], v[136:139], v[156:159], v[108:111]
  ds_read_b64_tr_b16 v[46:47], v4 offset:8704
  v_mfma_f32_16x16x32_bf16 v[124:127], v[140:143], v[156:159], v[124:127]
  v_mfma_f32_16x16x32_bf16 v[120:123], v[140:143], v[152:155], v[120:123]
  v_mfma_f32_16x16x32_bf16 v[116:119], v[140:143], v[148:151], v[116:119]
  v_mfma_f32_16x16x32_bf16 v[112:115], v[140:143], v[144:147], v[112:115]
  s_waitcnt lgkmcnt(0)
  v_mfma_f32_16x16x32_bf16 v[64:67], v[32:35], v[48:51], v[64:67]
  ds_read_b64_tr_b16 v[128:129], v5 offset:4096
  v_mfma_f32_16x16x32_bf16 v[68:71], v[32:35], v[52:55], v[68:71]
  ds_read_b64_tr_b16 v[130:131], v5 offset:4608
  v_mfma_f32_16x16x32_bf16 v[72:75], v[32:35], v[56:59], v[72:75]
  ds_read_b128 v[144:147], v2 offset:0
  v_mfma_f32_16x16x32_bf16 v[76:79], v[32:35], v[60:63], v[76:79]
  ds_read_b128 v[148:151], v2 offset:2048
  v_mfma_f32_16x16x32_bf16 v[92:95], v[36:39], v[60:63], v[92:95]
  ds_read_b128 v[152:155], v2 offset:4096
  v_mfma_f32_16x16x32_bf16 v[88:91], v[36:39], v[56:59], v[88:91]
  ds_read_b128 v[156:159], v2 offset:6144
  v_mfma_f32_16x16x32_bf16 v[84:87], v[36:39], v[52:55], v[84:87]
  ds_read_b64_tr_b16 v[132:133], v4 offset:4096
  v_mfma_f32_16x16x32_bf16 v[80:83], v[36:39], v[48:51], v[80:83]
  ds_read_b64_tr_b16 v[134:135], v4 offset:4608
  v_mfma_f32_16x16x32_bf16 v[96:99], v[40:43], v[48:51], v[96:99]
  ds_read_b64_tr_b16 v[136:137], v5 offset:12288
  v_mfma_f32_16x16x32_bf16 v[100:103], v[40:43], v[52:55], v[100:103]
  ds_read_b64_tr_b16 v[138:139], v5 offset:12800
  v_mfma_f32_16x16x32_bf16 v[104:107], v[40:43], v[56:59], v[104:107]
  ds_read_b64_tr_b16 v[140:141], v4 offset:12288
  v_mfma_f32_16x16x32_bf16 v[108:111], v[40:43], v[60:63], v[108:111]
  ds_read_b64_tr_b16 v[142:143], v4 offset:12800
  v_mfma_f32_16x16x32_bf16 v[124:127], v[44:47], v[60:63], v[124:127]
  v_add_u32 v2, 16384, v2
  v_add_u32 v5, 131072, v8
  v_mfma_f32_16x16x32_bf16 v[120:123], v[44:47], v[56:59], v[120:123]
  v_xor_b32 v4, 32, v5
  v_add_u32 v1, 16384, v1
  v_mfma_f32_16x16x32_bf16 v[116:119], v[44:47], v[52:55], v[116:119]
  v_mfma_f32_16x16x32_bf16 v[112:115], v[44:47], v[48:51], v[112:115]
  s_waitcnt vmcnt(0) lgkmcnt(0)
  s_barrier
  v_mfma_f32_16x16x32_bf16 v[64:67], v[128:131], v[144:147], v[64:67]
  ds_read_b64_tr_b16 v[32:33], v5 offset:0
  v_mfma_f32_16x16x32_bf16 v[68:71], v[128:131], v[148:151], v[68:71]
  ds_read_b64_tr_b16 v[34:35], v5 offset:512
  v_mfma_f32_16x16x32_bf16 v[72:75], v[128:131], v[152:155], v[72:75]
  ds_read_b128 v[48:51], v1 offset:0
  v_mfma_f32_16x16x32_bf16 v[76:79], v[128:131], v[156:159], v[76:79]
  ds_read_b128 v[52:55], v1 offset:2048
  v_mfma_f32_16x16x32_bf16 v[92:95], v[132:135], v[156:159], v[92:95]
  ds_read_b128 v[56:59], v1 offset:4096
  v_mfma_f32_16x16x32_bf16 v[88:91], v[132:135], v[152:155], v[88:91]
  ds_read_b128 v[60:63], v1 offset:6144
  v_mfma_f32_16x16x32_bf16 v[84:87], v[132:135], v[148:151], v[84:87]
  ds_read_b64_tr_b16 v[36:37], v4 offset:0
  v_mfma_f32_16x16x32_bf16 v[80:83], v[132:135], v[144:147], v[80:83]
  ds_read_b64_tr_b16 v[38:39], v4 offset:512
  v_mfma_f32_16x16x32_bf16 v[96:99], v[136:139], v[144:147], v[96:99]
  ds_read_b64_tr_b16 v[40:41], v5 offset:8192
  v_mfma_f32_16x16x32_bf16 v[100:103], v[136:139], v[148:151], v[100:103]
  ds_read_b64_tr_b16 v[42:43], v5 offset:8704
  v_mfma_f32_16x16x32_bf16 v[104:107], v[136:139], v[152:155], v[104:107]
  ds_read_b64_tr_b16 v[44:45], v4 offset:8192
  v_mfma_f32_16x16x32_bf16 v[108:111], v[136:139], v[156:159], v[108:111]
  ds_read_b64_tr_b16 v[46:47], v4 offset:8704
  v_mfma_f32_16x16x32_bf16 v[124:127], v[140:143], v[156:159], v[124:127]
  v_mfma_f32_16x16x32_bf16 v[120:123], v[140:143], v[152:155], v[120:123]
  v_mfma_f32_16x16x32_bf16 v[116:119], v[140:143], v[148:151], v[116:119]
  v_mfma_f32_16x16x32_bf16 v[112:115], v[140:143], v[144:147], v[112:115]
  s_waitcnt lgkmcnt(0)
  v_mfma_f32_16x16x32_bf16 v[64:67], v[32:35], v[48:51], v[64:67]
  ds_read_b64_tr_b16 v[128:129], v5 offset:4096
  v_mfma_f32_16x16x32_bf16 v[68:71], v[32:35], v[52:55], v[68:71]
  ds_read_b64_tr_b16 v[130:131], v5 offset:4608
  v_mfma_f32_16x16x32_bf16 v[72:75], v[32:35], v[56:59], v[72:75]
  ds_read_b128 v[144:147], v2 offset:0
  v_mfma_f32_16x16x32_bf16 v[76:79], v[32:35], v[60:63], v[76:79]
  ds_read_b128 v[148:151], v2 offset:2048
  v_mfma_f32_16x16x32_bf16 v[92:95], v[36:39], v[60:63], v[92:95]
  ds_read_b128 v[152:155], v2 offset:4096
  v_mfma_f32_16x16x32_bf16 v[88:91], v[36:39], v[56:59], v[88:91]
  ds_read_b128 v[156:159], v2 offset:6144
  v_mfma_f32_16x16x32_bf16 v[84:87], v[36:39], v[52:55], v[84:87]
  ds_read_b64_tr_b16 v[132:133], v4 offset:4096
  v_mfma_f32_16x16x32_bf16 v[80:83], v[36:39], v[48:51], v[80:83]
  ds_read_b64_tr_b16 v[134:135], v4 offset:4608
  v_mfma_f32_16x16x32_bf16 v[96:99], v[40:43], v[48:51], v[96:99]
  ds_read_b64_tr_b16 v[136:137], v5 offset:12288
  v_mfma_f32_16x16x32_bf16 v[100:103], v[40:43], v[52:55], v[100:103]
  ds_read_b64_tr_b16 v[138:139], v5 offset:12800
  v_mfma_f32_16x16x32_bf16 v[104:107], v[40:43], v[56:59], v[104:107]
  ds_read_b64_tr_b16 v[140:141], v4 offset:12288
  v_mfma_f32_16x16x32_bf16 v[108:111], v[40:43], v[60:63], v[108:111]
  ds_read_b64_tr_b16 v[142:143], v4 offset:12800
  v_mfma_f32_16x16x32_bf16 v[124:127], v[44:47], v[60:63], v[124:127]
  v_mfma_f32_16x16x32_bf16 v[120:123], v[44:47], v[56:59], v[120:123]
  v_mfma_f32_16x16x32_bf16 v[116:119], v[44:47], v[52:55], v[116:119]
  v_mfma_f32_16x16x32_bf16 v[112:115], v[44:47], v[48:51], v[112:115]
  s_waitcnt vmcnt(0) lgkmcnt(0)
L_S2:
  v_mfma_f32_16x16x32_bf16 v[64:67], v[128:131], v[144:147], v[64:67]
  v_mfma_f32_16x16x32_bf16 v[80:83], v[132:135], v[144:147], v[80:83]
  v_mfma_f32_16x16x32_bf16 v[96:99], v[136:139], v[144:147], v[96:99]
  v_mfma_f32_16x16x32_bf16 v[112:115], v[140:143], v[144:147], v[112:115]
  s_mov_b64 exec, 1
  ds_add_u32 v13, v14
  s_mov_b64 exec, -1
  v_mfma_f32_16x16x32_bf16 v[68:71], v[128:131], v[148:151], v[68:71]
  v_mfma_f32_16x16x32_bf16 v[84:87], v[132:135], v[148:151], v[84:87]
  v_mfma_f32_16x16x32_bf16 v[100:103], v[136:139], v[148:151], v[100:103]
  v_mfma_f32_16x16x32_bf16 v[116:119], v[140:143], v[148:151], v[116:119]
  buffer_load_dword v24, v23, s[68:71], 0 offen sc1
  v_mfma_f32_16x16x32_bf16 v[72:75], v[128:131], v[152:155], v[72:75]
  v_mfma_f32_16x16x32_bf16 v[88:91], v[132:135], v[152:155], v[88:91]
  v_mfma_f32_16x16x32_bf16 v[104:107], v[136:139], v[152:155], v[104:107]
  v_mfma_f32_16x16x32_bf16 v[120:123], v[140:143], v[152:155], v[120:123]
  v_mfma_f32_16x16x32_bf16 v[76:79], v[128:131], v[156:159], v[76:79]
  v_mfma_f32_16x16x32_bf16 v[92:95], v[132:135], v[156:159], v[92:95]
  v_mfma_f32_16x16x32_bf16 v[108:111], v[136:139], v[156:159], v[108:111]
  v_mfma_f32_16x16x32_bf16 v[124:127], v[140:143], v[156:159], v[124:127]
  v_readfirstlane_b32 s50, v12
  s_nop 1
  s_cmp_lg_u32 s50, 0
  s_cbranch_scc1 L_nonok_1
  s_mov_b32 s13, 131072
L_spin_2:
  global_load_dword v12, v11, s[46:47] sc1
  s_waitcnt vmcnt(0)
  v_readfirstlane_b32 s50, v12
  s_nop 1
  s_cmp_lg_u32 s50, 0
  s_cbranch_scc1 L_spinend_3
  s_sub_u32 s13, s13, 1
  s_cbranch_scc0 L_spin_2
L_spinend_3:
L_nonok_1:
  v_mul_f32 v32, s87, v64
  v_mul_f32 v33, s87, v65
  v_mul_f32 v34, s87, v66
  v_mul_f32 v35, s87, v67
  v_exp_f32 v32, v32
  v_exp_f32 v33, v33
  v_exp_f32 v34, v34
  v_exp_f32 v35, v35
  v_add_f32 v32, 1.0, v32
  v_add_f32 v33, 1.0, v33
  v_add_f32 v34, 1.0, v34
  v_add_f32 v35, 1.0, v35
  v_rcp_f32 v32, v32
  v_rcp_f32 v33, v33
  v_rcp_f32 v34, v34
  v_rcp_f32 v35, v35
  v_mul_f32 v32, v32, v96
  v_mul_f32 v33, v33, v97
  v_mul_f32 v34, v34, v98
  v_mul_f32 v35, v35, v99
  v_cvt_pk_bf16_f32 v40, v32, v33
  v_cvt_pk_bf16_f32 v41, v34, v35
  v_mul_f32 v36, s87, v80
  v_mul_f32 v37, s87, v81
  v_mul_f32 v38, s87, v82
  v_mul_f32 v39, s87, v83
  v_exp_f32 v36, v36
  v_exp_f32 v37, v37
  v_exp_f32 v38, v38
  v_exp_f32 v39, v39
  v_add_f32 v36, 1.0, v36
  v_add_f32 v37, 1.0, v37
  v_add_f32 v38, 1.0, v38
  v_add_f32 v39, 1.0, v39
  v_rcp_f32 v36, v36
  v_rcp_f32 v37, v37
  v_rcp_f32 v38, v38
  v_rcp_f32 v39, v39
  v_mul_f32 v36, v36, v112
  v_mul_f32 v37, v37, v113
  v_mul_f32 v38, v38, v114
  v_mul_f32 v39, v39, v115
  v_cvt_pk_bf16_f32 v42, v36, v37
  v_cvt_pk_bf16_f32 v43, v38, v39
  buffer_store_dwordx4 v[40:43], v6, s[68:71], s96 offen offset:0 sc1
  v_mul_f32 v32, s87, v68
  v_mul_f32 v33, s87, v69
  v_mul_f32 v34, s87, v70
  v_mul_f32 v35, s87, v71
  v_exp_f32 v32, v32
  v_exp_f32 v33, v33
  v_exp_f32 v34, v34
  v_exp_f32 v35, v35
  v_add_f32 v32, 1.0, v32
  v_add_f32 v33, 1.0, v33
  v_add_f32 v34, 1.0, v34
  v_add_f32 v35, 1.0, v35
  v_rcp_f32 v32, v32
  v_rcp_f32 v33, v33
  v_rcp_f32 v34, v34
  v_rcp_f32 v35, v35
  v_mul_f32 v32, v32, v100
  v_mul_f32 v33, v33, v101
  v_mul_f32 v34, v34, v102
  v_mul_f32 v35, v35, v103
  v_cvt_pk_bf16_f32 v44, v32, v33
  v_cvt_pk_bf16_f32 v45, v34, v35
  v_mul_f32 v36, s87, v84
  v_mul_f32 v37, s87, v85
  v_mul_f32 v38, s87, v86
  v_mul_f32 v39, s87, v87
  v_exp_f32 v36, v36
  v_exp_f32 v37, v37
  v_exp_f32 v38, v38
  v_exp_f32 v39, v39
  v_add_f32 v36, 1.0, v36
  v_add_f32 v37, 1.0, v37
  v_add_f32 v38, 1.0, v38
  v_add_f32 v39, 1.0, v39
  v_rcp_f32 v36, v36
  v_rcp_f32 v37, v37
  v_rcp_f32 v38, v38
  v_rcp_f32 v39, v39
  v_mul_f32 v36, v36, v116
  v_mul_f32 v37, v37, v117
  v_mul_f32 v38, v38, v118
  v_mul_f32 v39, v39, v119
  v_cvt_pk_bf16_f32 v46, v36, v37
  v_cvt_pk_bf16_f32 v47, v38, v39
  buffer_store_dwordx4 v[44:47], v6, s[68:71], s96 offen offset:1024 sc1
  s_waitcnt vmcnt(2)
  v_cmp_ne_u32 vcc, s50, v24
  s_cbranch_vccz L_ok_4
  s_mov_b32 s13, 131072
L_spin_5:
  buffer_load_dword v24, v23, s[68:71], 0 offen offset:0 sc1
  s_waitcnt vmcnt(0)
  v_cmp_ne_u32 vcc, s50, v24
  s_cbranch_vccz L_spinend_6
  s_sub_u32 s13, s13, 1
  s_cbranch_scc0 L_spin_5
L_spinend_6:
L_ok_4:
  s_bfe_u32 s10, s82, 0x40000
  s_lshl_b32 s10, s10, 14
  s_add_u32 s10, s10, s98
  buffer_load_dwordx4 v[160:163], v6, s[68:71], s10 offen offset:0 sc1
  v_mul_f32 v32, s87, v72
  v_mul_f32 v33, s87, v73
  v_mul_f32 v34, s87, v74
  v_mul_f32 v35, s87, v75
  v_exp_f32 v32, v32
  v_exp_f32 v33, v33
  v_exp_f32 v34, v34
  v_exp_f32 v35, v35
  v_add_f32 v32, 1.0, v32
  v_add_f32 v33, 1.0, v33
  v_add_f32 v34, 1.0, v34
  buffer_load_dwordx4 v[164:167], v6, s[68:71], s10 offen offset:1024 sc1
  v_add_f32 v35, 1.0, v35
  v_rcp_f32 v32, v32
  v_rcp_f32 v33, v33
  v_rcp_f32 v34, v34
  v_rcp_f32 v35, v35
  v_mul_f32 v32, v32, v104
  v_mul_f32 v33, v33, v105
  v_mul_f32 v34, v34, v106
  v_mul_f32 v35, v35, v107
  v_cvt_pk_bf16_f32 v40, v32, v33
  v_cvt_pk_bf16_f32 v41, v34, v35
  buffer_load_dwordx4 v[168:171], v6, s[68:71], s10 offen offset:2048 sc1
  v_mul_f32 v36, s87, v88
  v_mul_f32 v37, s87, v89
  v_mul_f32 v38, s87, v90
  v_mul_f32 v39, s87, v91
  v_exp_f32 v36, v36
  v_exp_f32 v37, v37
  v_exp_f32 v38, v38
  v_exp_f32 v39, v39
  v_add_f32 v36, 1.0, v36
  v_add_f32 v37, 1.0, v37
  buffer_load_dwordx4 v[172:175], v6, s[68:71], s10 offen offset:3072 sc1
  v_add_f32 v38, 1.0, v38
  v_add_f32 v39, 1.0, v39
  v_rcp_f32 v36, v36
  v_rcp_f32 v37, v37
  v_rcp_f32 v38, v38
  v_rcp_f32 v39, v39
  v_mul_f32 v36, v36, v120
  v_mul_f32 v37, v37, v121
  v_mul_f32 v38, v38, v122
  v_mul_f32 v39, v39, v123
  v_cvt_pk_bf16_f32 v42, v36, v37
  s_bfe_u32 s10, s82, 0x40004
  s_lshl_b32 s10, s10, 14
  s_add_u32 s10, s10, s98
  buffer_load_dwordx4 v[176:179], v6, s[68:71], s10 offen offset:0 sc1
  v_cvt_pk_bf16_f32 v43, v38, v39
  buffer_store_dwordx4 v[40:43], v6, s[68:71], s96 offen offset:2048 sc1
  v_mul_f32 v32, s87, v76
  v_mul_f32 v33, s87, v77
  v_mul_f32 v34, s87, v78
  v_mul_f32 v35, s87, v79
  v_exp_f32 v32, v32
  v_exp_f32 v33, v33
  v_exp_f32 v34, v34
  v_exp_f32 v35, v35
  buffer_load_dwordx4 v[180:183], v6, s[68:71], s10 offen offset:1024 sc1
  v_add_f32 v32, 1.0, v32
  v_add_f32 v33, 1.0, v33
  v_add_f32 v34, 1.0, v34
  v_add_f32 v35, 1.0, v35
  v_rcp_f32 v32, v32
  v_rcp_f32 v33, v33
  v_rcp_f32 v34, v34
  v_rcp_f32 v35, v35
  v_mul_f32 v32, v32, v108
  v_mul_f32 v33, v33, v109
  v_mul_f32 v34, v34, v110
  buffer_load_dwordx4 v[184:187], v6, s[68:71], s10 offen offset:2048 sc1
  v_mul_f32 v35, v35, v111
  v_cvt_pk_bf16_f32 v44, v32, v33
  v_cvt_pk_bf16_f32 v45, v34, v35
  v_mul_f32 v36, s87, v92
  v_mul_f32 v37, s87, v93
  v_mul_f32 v38, s87, v94
  v_mul_f32 v39, s87, v95
  v_exp_f32 v36, v36
  v_exp_f32 v37, v37
  v_exp_f32 v38, v38
  v_exp_f32 v39, v39
  buffer_load_dwordx4 v[188:191], v6, s[68:71], s10 offen offset:3072 sc1
  v_add_f32 v36, 1.0, v36
  v_add_f32 v37, 1.0, v37
  v_add_f32 v38, 1.0, v38
  v_add_f32 v39, 1.0, v39
  v_rcp_f32 v36, v36
  v_rcp_f32 v37, v37
  v_rcp_f32 v38, v38
  v_rcp_f32 v39, v39
  v_mul_f32 v36, v36, v124
  v_mul_f32 v37, v37, v125
  v_mul_f32 v38, v38, v126
  v_mul_f32 v39, v39, v127
  v_cvt_pk_bf16_f32 v46, v36, v37
  v_cvt_pk_bf16_f32 v47, v38, v39
  buffer_store_dwordx4 v[44:47], v6, s[68:71], s96 offen offset:3072 sc1
  s_bfe_u32 s10, s82, 0x40008
  s_lshl_b32 s10, s10, 14
  s_add_u32 s10, s10, s98
  buffer_load_dwordx4 v[192:195], v6, s[68:71], s10 offen offset:0 sc1
  buffer_load_dwordx4 v[196:199], v6, s[68:71], s10 offen offset:1024 sc1
  buffer_load_dwordx4 v[200:203], v6, s[68:71], s10 offen offset:2048 sc1
  buffer_load_dwordx4 v[204:207], v6, s[68:71], s10 offen offset:3072 sc1
  s_bfe_u32 s10, s82, 0x4000c
  s_lshl_b32 s10, s10, 14
  s_add_u32 s10, s10, s98
  buffer_load_dwordx4 v[208:211], v6, s[68:71], s10 offen offset:0 sc1
  buffer_load_dwordx4 v[212:215], v6, s[68:71], s10 offen offset:1024 sc1
  buffer_load_dwordx4 v[216:219], v6, s[68:71], s10 offen offset:2048 sc1
  buffer_load_dwordx4 v[220:223], v6, s[68:71], s10 offen offset:3072 sc1
  s_waitcnt vmcnt(8)
  s_mov_b32 exec_hi, 0
  buffer_store_dword v12, v7, s[68:71], s97 offen sc1
  s_mov_b32 exec_hi, -1
  s_bfe_u32 s10, s82, 0x40010
  s_lshl_b32 s10, s10, 14
  s_add_u32 s10, s10, s98
  buffer_load_dwordx4 v[224:227], v6, s[68:71], s10 offen offset:0 sc1
  buffer_load_dwordx4 v[228:231], v6, s[68:71], s10 offen offset:1024 sc1
  buffer_load_dwordx4 v[232:235], v6, s[68:71], s10 offen offset:2048 sc1
  buffer_load_dwordx4 v[236:239], v6, s[68:71], s10 offen offset:3072 sc1
  s_bfe_u32 s10, s82, 0x40014
  s_lshl_b32 s10, s10, 14
  s_add_u32 s10, s10, s98
  buffer_load_dwordx4 v[240:243], v6, s[68:71], s10 offen offset:0 sc1
  buffer_load_dwordx4 v[244:247], v6, s[68:71], s10 offen offset:1024 sc1
  buffer_load_dwordx4 v[248:251], v6, s[68:71], s10 offen offset:2048 sc1
  buffer_load_dwordx4 v[252:255], v6, s[68:71], s10 offen offset:3072 sc1
  s_bfe_u32 s10, s82, 0x40018
  s_lshl_b32 s10, s10, 14
  s_add_u32 s10, s10, s98
  buffer_load_dwordx4 v[128:131], v6, s[68:71], s10 offen offset:0 sc1
  buffer_load_dwordx4 v[132:135], v6, s[68:71], s10 offen offset:1024 sc1
  buffer_load_dwordx4 v[136:139], v6, s[68:71], s10 offen offset:2048 sc1
  buffer_load_dwordx4 v[140:143], v6, s[68:71], s10 offen offset:3072 sc1
  s_mov_b32 s13, 1048576
L_spin_7:
  ds_read_b32 v15, v13 offset:4
  s_waitcnt lgkmcnt(0)
  v_readfirstlane_b32 s9, v15
  s_nop 1
  s_cmp_ge_u32 s9, 4
  s_cbranch_scc1 L_spinend_8
  s_sub_u32 s13, s13, 1
  s_cbranch_scc0 L_spin_7
L_spinend_8:
  ds_read_b64_tr_b16 v[32:33], v17 offset:0
  ds_read_b64_tr_b16 v[34:35], v17 offset:2048
  ds_read_b64_tr_b16 v[36:37], v18 offset:0
  ds_read_b64_tr_b16 v[38:39], v18 offset:2048
  ds_read_b64_tr_b16 v[40:41], v19 offset:0
  ds_read_b64_tr_b16 v[42:43], v19 offset:2048
  ds_read_b64_tr_b16 v[44:45], v20 offset:0
  ds_read_b64_tr_b16 v[46:47], v20 offset:2048
  s_waitcnt lgkmcnt(0)
  v_mfma_f32_16x16x32_bf16 v[64:67], v[32:35], v[160:163], 0
  ds_read_b64_tr_b16 v[48:49], v17 offset:16384
  v_mfma_f32_16x16x32_bf16 v[68:71], v[32:35], v[164:167], 0
  ds_read_b64_tr_b16 v[50:51], v17 offset:18432
  s_add_u32 m0, s15, 131072
  s_bfe_u32 s78, s82, 0x40000
  s_mul_i32 s78, s78, 114688
  s_add_u32 s78, s78, 57344
  buffer_load_dwordx4 v9, s[64:67], s78 offen lds
  v_mfma_f32_16x16x32_bf16 v[84:87], v[36:39], v[164:167], 0
  ds_read_b64_tr_b16 v[52:53], v18 offset:16384
  v_mfma_f32_16x16x32_bf16 v[80:83], v[36:39], v[160:163], 0
  ds_read_b64_tr_b16 v[54:55], v18 offset:18432
  s_add_u32 m0, s15, 132096
  s_add_u32 s78, s78, 7168
  buffer_load_dwordx4 v9, s[64:67], s78 offen lds
  v_mfma_f32_16x16x32_bf16 v[96:99], v[40:43], v[160:163], 0
  ds_read_b64_tr_b16 v[56:57], v19 offset:16384
  v_mfma_f32_16x16x32_bf16 v[100:103], v[40:43], v[164:167], 0
  ds_read_b64_tr_b16 v[58:59], v19 offset:18432
  s_add_u32 m0, s15, 133120
  s_add_u32 s78, s78, 7168
  buffer_load_dwordx4 v9, s[64:67], s78 offen lds
  v_mfma_f32_16x16x32_bf16 v[116:119], v[44:47], v[164:167], 0
  ds_read_b64_tr_b16 v[60:61], v20 offset:16384
  v_mfma_f32_16x16x32_bf16 v[112:115], v[44:47], v[160:163], 0
  ds_read_b64_tr_b16 v[62:63], v20 offset:18432
  s_add_u32 m0, s15, 134144
  s_add_u32 s78, s78, 7168
  buffer_load_dwordx4 v9, s[64:67], s78 offen lds
  v_mfma_f32_16x16x32_bf16 v[72:75], v[32:35], v[168:171], 0
  v_mfma_f32_16x16x32_bf16 v[76:79], v[32:35], v[172:175], 0
  s_add_u32 m0, s15, 0
  s_bfe_u32 s78, s82, 0x40004
  s_mul_i32 s78, s78, 114688
  s_add_u32 s78, s78, 57344
  buffer_load_dwordx4 v9, s[64:67], s78 offen lds
  v_mfma_f32_16x16x32_bf16 v[92:95], v[36:39], v[172:175], 0
  v_mfma_f32_16x16x32_bf16 v[88:91], v[36:39], v[168:171], 0
  s_add_u32 m0, s15, 1024
  s_add_u32 s78, s78, 7168
  buffer_load_dwordx4 v9, s[64:67], s78 offen lds
  v_mfma_f32_16x16x32_bf16 v[104:107], v[40:43], v[168:171], 0
  v_mfma_f32_16x16x32_bf16 v[108:111], v[40:43], v[172:175], 0
  s_add_u32 m0, s15, 2048
  s_add_u32 s78, s78, 7168
  buffer_load_dwordx4 v9, s[64:67], s78 offen lds
  v_mfma_f32_16x16x32_bf16 v[124:127], v[44:47], v[172:175], 0
  v_mfma_f32_16x16x32_bf16 v[120:123], v[44:47], v[168:171], 0
  s_add_u32 m0, s15, 3072
  s_add_u32 s78, s78, 7168
  buffer_load_dwordx4 v9, s[64:67], s78 offen lds
  s_waitcnt lgkmcnt(0)
  v_mfma_f32_16x16x32_bf16 v[64:67], v[48:51], v[176:179], v[64:67]
  v_add_u32 v17, 131072, v17
  ds_read_b64_tr_b16 v[32:33], v17 offset:16384
  v_mfma_f32_16x16x32_bf16 v[68:71], v[48:51], v[180:183], v[68:71]
  ds_read_b64_tr_b16 v[34:35], v17 offset:18432
  v_mfma_f32_16x16x32_bf16 v[84:87], v[52:55], v[180:183], v[84:87]
  v_add_u32 v18, 131072, v18
  ds_read_b64_tr_b16 v[36:37], v18 offset:16384
  v_mfma_f32_16x16x32_bf16 v[80:83], v[52:55], v[176:179], v[80:83]
  ds_read_b64_tr_b16 v[38:39], v18 offset:18432
  v_mfma_f32_16x16x32_bf16 v[96:99], v[56:59], v[176:179], v[96:99]
  v_add_u32 v19, 131072, v19
  ds_read_b64_tr_b16 v[40:41], v19 offset:16384
  v_mfma_f32_16x16x32_bf16 v[100:103], v[56:59], v[180:183], v[100:103]
  ds_read_b64_tr_b16 v[42:43], v19 offset:18432
  v_mfma_f32_16x16x32_bf16 v[116:119], v[60:63], v[180:183], v[116:119]
  v_add_u32 v20, 131072, v20
  ds_read_b64_tr_b16 v[44:45], v20 offset:16384
  v_mfma_f32_16x16x32_bf16 v[112:115], v[60:63], v[176:179], v[112:115]
  ds_read_b64_tr_b16 v[46:47], v20 offset:18432
  v_mfma_f32_16x16x32_bf16 v[72:75], v[48:51], v[184:187], v[72:75]
  v_mfma_f32_16x16x32_bf16 v[76:79], v[48:51], v[188:191], v[76:79]
  s_add_u32 m0, s15, 16384
  s_bfe_u32 s78, s82, 0x40008
  s_mul_i32 s78, s78, 114688
  s_add_u32 s78, s78, 57344
  buffer_load_dwordx4 v9, s[64:67], s78 offen lds
  v_mfma_f32_16x16x32_bf16 v[92:95], v[52:55], v[188:191], v[92:95]
  v_mfma_f32_16x16x32_bf16 v[88:91], v[52:55], v[184:187], v[88:91]
  s_add_u32 m0, s15, 17408
  s_add_u32 s78, s78, 7168
  buffer_load_dwordx4 v9, s[64:67], s78 offen lds
  v_mfma_f32_16x16x32_bf16 v[104:107], v[56:59], v[184:187], v[104:107]
  v_mfma_f32_16x16x32_bf16 v[108:111], v[56:59], v[188:191], v[108:111]
  s_add_u32 m0, s15, 18432
  s_add_u32 s78, s78, 7168
  buffer_load_dwordx4 v9, s[64:67], s78 offen lds
  v_mfma_f32_16x16x32_bf16 v[124:127], v[60:63], v[188:191], v[124:127]
  v_mfma_f32_16x16x32_bf16 v[120:123], v[60:63], v[184:187], v[120:123]
  s_add_u32 m0, s15, 19456
  s_add_u32 s78, s78, 7168
  buffer_load_dwordx4 v9, s[64:67], s78 offen lds
  s_waitcnt vmcnt(31)
  s_waitcnt lgkmcnt(0)
  v_mfma_f32_16x16x32_bf16 v[64:67], v[32:35], v[192:195], v[64:67]
  v_add_u32 v17, 4294901760, v17
  ds_read_b64_tr_b16 v[48:49], v17 offset:0
  v_mfma_f32_16x16x32_bf16 v[68:71], v[32:35], v[196:199], v[68:71]
  ds_read_b64_tr_b16 v[50:51], v17 offset:2048
  v_mfma_f32_16x16x32_bf16 v[84:87], v[36:39], v[196:199], v[84:87]
  v_add_u32 v18, 4294901760, v18
  ds_read_b64_tr_b16 v[52:53], v18 offset:0
  v_mfma_f32_16x16x32_bf16 v[80:83], v[36:39], v[192:195], v[80:83]
  ds_read_b64_tr_b16 v[54:55], v18 offset:2048
  v_mfma_f32_16x16x32_bf16 v[96:99], v[40:43], v[192:195], v[96:99]
  v_add_u32 v19, 4294901760, v19
  ds_read_b64_tr_b16 v[56:57], v19 offset:0
  v_mfma_f32_16x16x32_bf16 v[100:103], v[40:43], v[196:199], v[100:103]
  ds_read_b64_tr_b16 v[58:59], v19 offset:2048
  v_mfma_f32_16x16x32_bf16 v[116:119], v[44:47], v[196:199], v[116:119]
  v_add_u32 v20, 4294901760, v20
  ds_read_b64_tr_b16 v[60:61], v20 offset:0
  v_mfma_f32_16x16x32_bf16 v[112:115], v[44:47], v[192:195], v[112:115]
  ds_read_b64_tr_b16 v[62:63], v20 offset:2048
  s_waitcnt vmcnt(29)
  v_mfma_f32_16x16x32_bf16 v[72:75], v[32:35], v[200:203], v[72:75]
  v_mfma_f32_16x16x32_bf16 v[76:79], v[32:35], v[204:207], v[76:79]
  s_add_u32 m0, s15, 147456
  s_bfe_u32 s78, s82, 0x4000c
  s_mul_i32 s78, s78, 114688
  s_add_u32 s78, s78, 57344
  buffer_load_dwordx4 v9, s[64:67], s78 offen lds
  v_mfma_f32_16x16x32_bf16 v[92:95], v[36:39], v[204:207], v[92:95]
  v_mfma_f32_16x16x32_bf16 v[88:91], v[36:39], v[200:203], v[88:91]
  s_add_u32 m0, s15, 148480
  s_add_u32 s78, s78, 7168
  buffer_load_dwordx4 v9, s[64:67], s78 offen lds
  v_mfma_f32_16x16x32_bf16 v[104:107], v[40:43], v[200:203], v[104:107]
  v_mfma_f32_16x16x32_bf16 v[108:111], v[40:43], v[204:207], v[108:111]
  s_add_u32 m0, s15, 149504
  s_add_u32 s78, s78, 7168
  buffer_load_dwordx4 v9, s[64:67], s78 offen lds
  v_mfma_f32_16x16x32_bf16 v[124:127], v[44:47], v[204:207], v[124:127]
  v_mfma_f32_16x16x32_bf16 v[120:123], v[44:47], v[200:203], v[120:123]
  s_add_u32 m0, s15, 150528
  s_add_u32 s78, s78, 7168
  buffer_load_dwordx4 v9, s[64:67], s78 offen lds
  s_waitcnt vmcnt(31)
  s_waitcnt lgkmcnt(0)
  v_mfma_f32_16x16x32_bf16 v[64:67], v[48:51], v[208:211], v[64:67]
  ds_read_b64_tr_b16 v[32:33], v17 offset:49152
  v_mfma_f32_16x16x32_bf16 v[68:71], v[48:51], v[212:215], v[68:71]
  ds_read_b64_tr_b16 v[34:35], v17 offset:51200
  buffer_load_dword v24, v23, s[68:71], 0 offen offset:512 sc1
  v_mfma_f32_16x16x32_bf16 v[84:87], v[52:55], v[212:215], v[84:87]
  ds_read_b64_tr_b16 v[36:37], v18 offset:49152
  v_mfma_f32_16x16x32_bf16 v[80:83], v[52:55], v[208:211], v[80:83]
  ds_read_b64_tr_b16 v[38:39], v18 offset:51200
  v_mfma_f32_16x16x32_bf16 v[96:99], v[56:59], v[208:211], v[96:99]
  ds_read_b64_tr_b16 v[40:41], v19 offset:49152
  v_mfma_f32_16x16x32_bf16 v[100:103], v[56:59], v[212:215], v[100:103]
  ds_read_b64_tr_b16 v[42:43], v19 offset:51200
  v_mfma_f32_16x16x32_bf16 v[116:119], v[60:63], v[212:215], v[116:119]
  ds_read_b64_tr_b16 v[44:45], v20 offset:49152
  v_mfma_f32_16x16x32_bf16 v[112:115], v[60:63], v[208:211], v[112:115]
  ds_read_b64_tr_b16 v[46:47], v20 offset:51200
  s_waitcnt vmcnt(30)
  v_mfma_f32_16x16x32_bf16 v[72:75], v[48:51], v[216:219], v[72:75]
  v_mfma_f32_16x16x32_bf16 v[76:79], v[48:51], v[220:223], v[76:79]
  s_add_u32 m0, s15, 65536
  s_bfe_u32 s78, s82, 0x40010
  s_mul_i32 s78, s78, 114688
  s_add_u32 s78, s78, 57344
  buffer_load_dwordx4 v9, s[64:67], s78 offen lds
  v_mfma_f32_16x16x32_bf16 v[92:95], v[52:55], v[220:223], v[92:95]
  v_mfma_f32_16x16x32_bf16 v[88:91], v[52:55], v[216:219], v[88:91]
  s_add_u32 m0, s15, 66560
  s_add_u32 s78, s78, 7168
  buffer_load_dwordx4 v9, s[64:67], s78 offen lds
  v_mfma_f32_16x16x32_bf16 v[104:107], v[56:59], v[216:219], v[104:107]
  v_mfma_f32_16x16x32_bf16 v[108:111], v[56:59], v[220:223], v[108:111]
  s_add_u32 m0, s15, 67584
  s_add_u32 s78, s78, 7168
  buffer_load_dwordx4 v9, s[64:67], s78 offen lds
  v_mfma_f32_16x16x32_bf16 v[124:127], v[60:63], v[220:223], v[124:127]
  v_mfma_f32_16x16x32_bf16 v[120:123], v[60:63], v[216:219], v[120:123]
  s_add_u32 m0, s15, 68608
  s_add_u32 s78, s78, 7168
  buffer_load_dwordx4 v9, s[64:67], s78 offen lds
  s_waitcnt vmcnt(31)
  s_waitcnt lgkmcnt(0)
  v_mfma_f32_16x16x32_bf16 v[64:67], v[32:35], v[224:227], v[64:67]
  ds_read_b64_tr_b16 v[48:49], v17 offset:16384
  v_mfma_f32_16x16x32_bf16 v[68:71], v[32:35], v[228:231], v[68:71]
  ds_read_b64_tr_b16 v[50:51], v17 offset:18432
  v_mfma_f32_16x16x32_bf16 v[84:87], v[36:39], v[228:231], v[84:87]
  ds_read_b64_tr_b16 v[52:53], v18 offset:16384
  v_mfma_f32_16x16x32_bf16 v[80:83], v[36:39], v[224:227], v[80:83]
  ds_read_b64_tr_b16 v[54:55], v18 offset:18432
  v_mfma_f32_16x16x32_bf16 v[96:99], v[40:43], v[224:227], v[96:99]
  ds_read_b64_tr_b16 v[56:57], v19 offset:16384
  v_mfma_f32_16x16x32_bf16 v[100:103], v[40:43], v[228:231], v[100:103]
  ds_read_b64_tr_b16 v[58:59], v19 offset:18432
  v_mfma_f32_16x16x32_bf16 v[116:119], v[44:47], v[228:231], v[116:119]
  ds_read_b64_tr_b16 v[60:61], v20 offset:16384
  v_mfma_f32_16x16x32_bf16 v[112:115], v[44:47], v[224:227], v[112:115]
  ds_read_b64_tr_b16 v[62:63], v20 offset:18432
  s_waitcnt vmcnt(29)
  v_mfma_f32_16x16x32_bf16 v[72:75], v[32:35], v[232:235], v[72:75]
  v_mfma_f32_16x16x32_bf16 v[76:79], v[32:35], v[236:239], v[76:79]
  s_add_u32 m0, s15, 114688
  s_bfe_u32 s78, s82, 0x40014
  s_mul_i32 s78, s78, 114688
  s_add_u32 s78, s78, 57344
  buffer_load_dwordx4 v9, s[64:67], s78 offen lds
  v_mfma_f32_16x16x32_bf16 v[92:95], v[36:39], v[236:239], v[92:95]
  v_mfma_f32_16x16x32_bf16 v[88:91], v[36:39], v[232:235], v[88:91]
  s_add_u32 m0, s15, 115712
  s_add_u32 s78, s78, 7168
  buffer_load_dwordx4 v9, s[64:67], s78 offen lds
  v_mfma_f32_16x16x32_bf16 v[104:107], v[40:43], v[232:235], v[104:107]
  v_mfma_f32_16x16x32_bf16 v[108:111], v[40:43], v[236:239], v[108:111]
  s_add_u32 m0, s15, 116736
  s_add_u32 s78, s78, 7168
  buffer_load_dwordx4 v9, s[64:67], s78 offen lds
  v_mfma_f32_16x16x32_bf16 v[124:127], v[44:47], v[236:239], v[124:127]
  v_mfma_f32_16x16x32_bf16 v[120:123], v[44:47], v[232:235], v[120:123]
  s_add_u32 m0, s15, 117760
  s_add_u32 s78, s78, 7168
  buffer_load_dwordx4 v9, s[64:67], s78 offen lds
  s_waitcnt vmcnt(8)
  v_cmp_ne_u32 vcc, s50, v24
  s_cbranch_vccz L_ok_9
  s_mov_b32 s13, 131072
L_spin_10:
  buffer_load_dword v24, v23, s[68:71], 0 offen offset:512 sc1
  s_waitcnt vmcnt(0)
  v_cmp_ne_u32 vcc, s50, v24
  s_cbranch_vccz L_spinend_11
  s_sub_u32 s13, s13, 1
  s_cbranch_scc0 L_spin_10
L_spinend_11:
L_ok_9:
  s_add_u32 s98, s98, 8192
  s_bfe_u32 s10, s82, 0x40000
  s_lshl_b32 s10, s10, 14
  s_add_u32 s10, s10, s98
  buffer_load_dwordx4 v[144:147], v6, s[68:71], s10 offen offset:0 sc1
  buffer_load_dwordx4 v[148:151], v6, s[68:71], s10 offen offset:1024 sc1
  buffer_load_dwordx4 v[152:155], v6, s[68:71], s10 offen offset:2048 sc1
  buffer_load_dwordx4 v[156:159], v6, s[68:71], s10 offen offset:3072 sc1
  s_bfe_u32 s10, s82, 0x40004
  s_lshl_b32 s10, s10, 14
  s_add_u32 s10, s10, s98
  buffer_load_dwordx4 v[160:163], v6, s[68:71], s10 offen offset:0 sc1
  buffer_load_dwordx4 v[164:167], v6, s[68:71], s10 offen offset:1024 sc1
  buffer_load_dwordx4 v[168:171], v6, s[68:71], s10 offen offset:2048 sc1
  buffer_load_dwordx4 v[172:175], v6, s[68:71], s10 offen offset:3072 sc1
  s_waitcnt lgkmcnt(0)
  v_mfma_f32_16x16x32_bf16 v[64:67], v[48:51], v[240:243], v[64:67]
  ds_read_b64_tr_b16 v[32:33], v17 offset:32768
  v_mfma_f32_16x16x32_bf16 v[68:71], v[48:51], v[244:247], v[68:71]
  ds_read_b64_tr_b16 v[34:35], v17 offset:34816
  v_mfma_f32_16x16x32_bf16 v[84:87], v[52:55], v[244:247], v[84:87]
  ds_read_b64_tr_b16 v[36:37], v18 offset:32768
  v_mfma_f32_16x16x32_bf16 v[80:83], v[52:55], v[240:243], v[80:83]
  ds_read_b64_tr_b16 v[38:39], v18 offset:34816
  v_mfma_f32_16x16x32_bf16 v[96:99], v[56:59], v[240:243], v[96:99]
  ds_read_b64_tr_b16 v[40:41], v19 offset:32768
  v_mfma_f32_16x16x32_bf16 v[100:103], v[56:59], v[244:247], v[100:103]
  ds_read_b64_tr_b16 v[42:43], v19 offset:34816
  v_mfma_f32_16x16x32_bf16 v[116:119], v[60:63], v[244:247], v[116:119]
  ds_read_b64_tr_b16 v[44:45], v20 offset:32768
  v_mfma_f32_16x16x32_bf16 v[112:115], v[60:63], v[240:243], v[112:115]
  ds_read_b64_tr_b16 v[46:47], v20 offset:34816
  v_mfma_f32_16x16x32_bf16 v[72:75], v[48:51], v[248:251], v[72:75]
  v_mfma_f32_16x16x32_bf16 v[76:79], v[48:51], v[252:255], v[76:79]
  s_bfe_u32 s10, s82, 0x40008
  s_lshl_b32 s10, s10, 14
  s_add_u32 s10, s10, s98
  buffer_load_dwordx4 v[176:179], v6, s[68:71], s10 offen offset:0 sc1
  v_mfma_f32_16x16x32_bf16 v[92:95], v[52:55], v[252:255], v[92:95]
  v_mfma_f32_16x16x32_bf16 v[88:91], v[52:55], v[248:251], v[88:91]
  buffer_load_dwordx4 v[180:183], v6, s[68:71], s10 offen offset:1024 sc1
  v_mfma_f32_16x16x32_bf16 v[104:107], v[56:59], v[248:251], v[104:107]
  v_mfma_f32_16x16x32_bf16 v[108:111], v[56:59], v[252:255], v[108:111]
  buffer_load_dwordx4 v[184:187], v6, s[68:71], s10 offen offset:2048 sc1
  v_mfma_f32_16x16x32_bf16 v[124:127], v[60:63], v[252:255], v[124:127]
  v_mfma_f32_16x16x32_bf16 v[120:123], v[60:63], v[248:251], v[120:123]
  buffer_load_dwordx4 v[188:191], v6, s[68:71], s10 offen offset:3072 sc1
  s_waitcnt lgkmcnt(0)
  v_mfma_f32_16x16x32_bf16 v[64:67], v[32:35], v[128:131], v[64:67]
  v_add_u32 v17, 65536, v17
  ds_read_b64_tr_b16 v[48:49], v17 offset:0
  v_mfma_f32_16x16x32_bf16 v[68:71], v[32:35], v[132:135], v[68:71]
  ds_read_b64_tr_b16 v[50:51], v17 offset:2048
  s_add_u32 m0, s15, 81920
  s_bfe_u32 s78, s82, 0x40018
  s_mul_i32 s78, s78, 114688
  s_add_u32 s78, s78, 57344
  buffer_load_dwordx4 v9, s[64:67], s78 offen lds
  v_mfma_f32_16x16x32_bf16 v[84:87], v[36:39], v[132:135], v[84:87]
  v_add_u32 v18, 65536, v18
  ds_read_b64_tr_b16 v[52:53], v18 offset:0
  v_mfma_f32_16x16x32_bf16 v[80:83], v[36:39], v[128:131], v[80:83]
  ds_read_b64_tr_b16 v[54:55], v18 offset:2048
  s_add_u32 m0, s15, 82944
  s_add_u32 s78, s78, 7168
  buffer_load_dwordx4 v9, s[64:67], s78 offen lds
  v_mfma_f32_16x16x32_bf16 v[96:99], v[40:43], v[128:131], v[96:99]
  v_add_u32 v19, 65536, v19
  ds_read_b64_tr_b16 v[56:57], v19 offset:0
  v_mfma_f32_16x16x32_bf16 v[100:103], v[40:43], v[132:135], v[100:103]
  ds_read_b64_tr_b16 v[58:59], v19 offset:2048
  s_add_u32 m0, s15, 83968
  s_add_u32 s78, s78, 7168
  buffer_load_dwordx4 v9, s[64:67], s78 offen lds
  v_mfma_f32_16x16x32_bf16 v[116:119], v[44:47], v[132:135], v[116:119]
  v_add_u32 v20, 65536, v20
  ds_read_b64_tr_b16 v[60:61], v20 offset:0
  v_mfma_f32_16x16x32_bf16 v[112:115], v[44:47], v[128:131], v[112:115]
  ds_read_b64_tr_b16 v[62:63], v20 offset:2048
  s_add_u32 m0, s15, 84992
  s_add_u32 s78, s78, 7168
  buffer_load_dwordx4 v9, s[64:67], s78 offen lds
  v_mfma_f32_16x16x32_bf16 v[72:75], v[32:35], v[136:139], v[72:75]
  v_mfma_f32_16x16x32_bf16 v[76:79], v[32:35], v[140:143], v[76:79]
  s_bfe_u32 s10, s82, 0x4000c
  s_lshl_b32 s10, s10, 14
  s_add_u32 s10, s10, s98
  buffer_load_dwordx4 v[192:195], v6, s[68:71], s10 offen offset:0 sc1
  v_mfma_f32_16x16x32_bf16 v[92:95], v[36:39], v[140:143], v[92:95]
  v_mfma_f32_16x16x32_bf16 v[88:91], v[36:39], v[136:139], v[88:91]
  buffer_load_dwordx4 v[196:199], v6, s[68:71], s10 offen offset:1024 sc1
  v_mfma_f32_16x16x32_bf16 v[104:107], v[40:43], v[136:139], v[104:107]
  v_mfma_f32_16x16x32_bf16 v[108:111], v[40:43], v[140:143], v[108:111]
  buffer_load_dwordx4 v[200:203], v6, s[68:71], s10 offen offset:2048 sc1
  v_mfma_f32_16x16x32_bf16 v[124:127], v[44:47], v[140:143], v[124:127]
  v_mfma_f32_16x16x32_bf16 v[120:123], v[44:47], v[136:139], v[120:123]
  buffer_load_dwordx4 v[204:207], v6, s[68:71], s10 offen offset:3072 sc1
  s_waitcnt vmcnt(18)
  s_waitcnt lgkmcnt(0)
  v_mfma_f32_16x16x32_bf16 v[64:67], v[48:51], v[144:147], v[64:67]
  v_add_u32 v17, 4294836224, v17
  ds_read_b64_tr_b16 v[32:33], v17 offset:0
  v_mfma_f32_16x16x32_bf16 v[68:71], v[48:51], v[148:151], v[68:71]
  ds_read_b64_tr_b16 v[34:35], v17 offset:2048
  v_mfma_f32_16x16x32_bf16 v[84:87], v[52:55], v[148:151], v[84:87]
  v_add_u32 v18, 4294836224, v18
  ds_read_b64_tr_b16 v[36:37], v18 offset:0
  v_mfma_f32_16x16x32_bf16 v[80:83], v[52:55], v[144:147], v[80:83]
  ds_read_b64_tr_b16 v[38:39], v18 offset:2048
  v_mfma_f32_16x16x32_bf16 v[96:99], v[56:59], v[144:147], v[96:99]
  v_add_u32 v19, 4294836224, v19
  ds_read_b64_tr_b16 v[40:41], v19 offset:0
  v_mfma_f32_16x16x32_bf16 v[100:103], v[56:59], v[148:151], v[100:103]
  ds_read_b64_tr_b16 v[42:43], v19 offset:2048
  v_mfma_f32_16x16x32_bf16 v[116:119], v[60:63], v[148:151], v[116:119]
  v_add_u32 v20, 4294836224, v20
  ds_read_b64_tr_b16 v[44:45], v20 offset:0
  v_mfma_f32_16x16x32_bf16 v[112:115], v[60:63], v[144:147], v[112:115]
  ds_read_b64_tr_b16 v[46:47], v20 offset:2048
  s_waitcnt vmcnt(16)
  v_mfma_f32_16x16x32_bf16 v[72:75], v[48:51], v[152:155], v[72:75]
  v_mfma_f32_16x16x32_bf16 v[76:79], v[48:51], v[156:159], v[76:79]
  s_bfe_u32 s10, s82, 0x40010
  s_lshl_b32 s10, s10, 14
  s_add_u32 s10, s10, s98
  buffer_load_dwordx4 v[208:211], v6, s[68:71], s10 offen offset:0 sc1
  v_mfma_f32_16x16x32_bf16 v[92:95], v[52:55], v[156:159], v[92:95]
  v_mfma_f32_16x16x32_bf16 v[88:91], v[52:55], v[152:155], v[88:91]
  buffer_load_dwordx4 v[212:215], v6, s[68:71], s10 offen offset:1024 sc1
  v_mfma_f32_16x16x32_bf16 v[104:107], v[56:59], v[152:155], v[104:107]
  v_mfma_f32_16x16x32_bf16 v[108:111], v[56:59], v[156:159], v[108:111]
  buffer_load_dwordx4 v[216:219], v6, s[68:71], s10 offen offset:2048 sc1
  v_mfma_f32_16x16x32_bf16 v[124:127], v[60:63], v[156:159], v[124:127]
  v_mfma_f32_16x16x32_bf16 v[120:123], v[60:63], v[152:155], v[120:123]
  buffer_load_dwordx4 v[220:223], v6, s[68:71], s10 offen offset:3072 sc1
  s_waitcnt vmcnt(18)
  s_waitcnt lgkmcnt(0)
  v_mfma_f32_16x16x32_bf16 v[64:67], v[32:35], v[160:163], v[64:67]
  ds_read_b64_tr_b16 v[48:49], v17 offset:16384
  v_mfma_f32_16x16x32_bf16 v[68:71], v[32:35], v[164:167], v[68:71]
  ds_read_b64_tr_b16 v[50:51], v17 offset:18432
  v_mfma_f32_16x16x32_bf16 v[84:87], v[36:39], v[164:167], v[84:87]
  ds_read_b64_tr_b16 v[52:53], v18 offset:16384
  v_mfma_f32_16x16x32_bf16 v[80:83], v[36:39], v[160:163], v[80:83]
  ds_read_b64_tr_b16 v[54:55], v18 offset:18432
  v_mfma_f32_16x16x32_bf16 v[96:99], v[40:43], v[160:163], v[96:99]
  ds_read_b64_tr_b16 v[56:57], v19 offset:16384
  v_mfma_f32_16x16x32_bf16 v[100:103], v[40:43], v[164:167], v[100:103]
  ds_read_b64_tr_b16 v[58:59], v19 offset:18432
  v_mfma_f32_16x16x32_bf16 v[116:119], v[44:47], v[164:167], v[116:119]
  ds_read_b64_tr_b16 v[60:61], v20 offset:16384
  v_mfma_f32_16x16x32_bf16 v[112:115], v[44:47], v[160:163], v[112:115]
  ds_read_b64_tr_b16 v[62:63], v20 offset:18432
  s_waitcnt vmcnt(16)
  v_mfma_f32_16x16x32_bf16 v[72:75], v[32:35], v[168:171], v[72:75]
  v_mfma_f32_16x16x32_bf16 v[76:79], v[32:35], v[172:175], v[76:79]
  s_bfe_u32 s10, s82, 0x40014
  s_lshl_b32 s10, s10, 14
  s_add_u32 s10, s10, s98
  buffer_load_dwordx4 v[224:227], v6, s[68:71], s10 offen offset:0 sc1
  v_mfma_f32_16x16x32_bf16 v[92:95], v[36:39], v[172:175], v[92:95]
  v_mfma_f32_16x16x32_bf16 v[88:91], v[36:39], v[168:171], v[88:91]
  buffer_load_dwordx4 v[228:231], v6, s[68:71], s10 offen offset:1024 sc1
  v_mfma_f32_16x16x32_bf16 v[104:107], v[40:43], v[168:171], v[104:107]
  v_mfma_f32_16x16x32_bf16 v[108:111], v[40:43], v[172:175], v[108:111]
  buffer_load_dwordx4 v[232:235], v6, s[68:71], s10 offen offset:2048 sc1
  v_mfma_f32_16x16x32_bf16 v[124:127], v[44:47], v[172:175], v[124:127]
  v_mfma_f32_16x16x32_bf16 v[120:123], v[44:47], v[168:171], v[120:123]
  buffer_load_dwordx4 v[236:239], v6, s[68:71], s10 offen offset:3072 sc1
  s_mov_b64 exec, 1
  ds_add_u32 v13, v14 offset:8
  s_mov_b64 exec, -1
  s_waitcnt vmcnt(18)
  s_waitcnt lgkmcnt(0)
  v_mfma_f32_16x16x32_bf16 v[64:67], v[48:51], v[176:179], v[64:67]
  v_add_u32 v17, 131072, v17
  ds_read_b64_tr_b16 v[32:33], v17 offset:16384
  v_mfma_f32_16x16x32_bf16 v[68:71], v[48:51], v[180:183], v[68:71]
  ds_read_b64_tr_b16 v[34:35], v17 offset:18432
  v_mfma_f32_16x16x32_bf16 v[84:87], v[52:55], v[180:183], v[84:87]
  v_add_u32 v18, 131072, v18
  ds_read_b64_tr_b16 v[36:37], v18 offset:16384
  v_mfma_f32_16x16x32_bf16 v[80:83], v[52:55], v[176:179], v[80:83]
  ds_read_b64_tr_b16 v[38:39], v18 offset:18432
  v_mfma_f32_16x16x32_bf16 v[96:99], v[56:59], v[176:179], v[96:99]
  v_add_u32 v19, 131072, v19
  ds_read_b64_tr_b16 v[40:41], v19 offset:16384
  v_mfma_f32_16x16x32_bf16 v[100:103], v[56:59], v[180:183], v[100:103]
  ds_read_b64_tr_b16 v[42:43], v19 offset:18432
  v_mfma_f32_16x16x32_bf16 v[116:119], v[60:63], v[180:183], v[116:119]
  v_add_u32 v20, 131072, v20
  ds_read_b64_tr_b16 v[44:45], v20 offset:16384
  v_mfma_f32_16x16x32_bf16 v[112:115], v[60:63], v[176:179], v[112:115]
  ds_read_b64_tr_b16 v[46:47], v20 offset:18432
  s_waitcnt vmcnt(16)
  v_mfma_f32_16x16x32_bf16 v[72:75], v[48:51], v[184:187], v[72:75]
  v_mfma_f32_16x16x32_bf16 v[76:79], v[48:51], v[188:191], v[76:79]
  s_bfe_u32 s10, s82, 0x40018
  s_lshl_b32 s10, s10, 14
  s_add_u32 s10, s10, s98
  buffer_load_dwordx4 v[240:243], v6, s[68:71], s10 offen offset:0 sc1
  v_mfma_f32_16x16x32_bf16 v[92:95], v[52:55], v[188:191], v[92:95]
  v_mfma_f32_16x16x32_bf16 v[88:91], v[52:55], v[184:187], v[88:91]
  buffer_load_dwordx4 v[244:247], v6, s[68:71], s10 offen offset:1024 sc1
  v_mfma_f32_16x16x32_bf16 v[104:107], v[56:59], v[184:187], v[104:107]
  v_mfma_f32_16x16x32_bf16 v[108:111], v[56:59], v[188:191], v[108:111]
  buffer_load_dwordx4 v[248:251], v6, s[68:71], s10 offen offset:2048 sc1
  v_mfma_f32_16x16x32_bf16 v[124:127], v[60:63], v[188:191], v[124:127]
  v_mfma_f32_16x16x32_bf16 v[120:123], v[60:63], v[184:187], v[120:123]
  buffer_load_dwordx4 v[252:255], v6, s[68:71], s10 offen offset:3072 sc1
  s_waitcnt vmcnt(14)
  s_waitcnt lgkmcnt(0)
  v_mfma_f32_16x16x32_bf16 v[64:67], v[32:35], v[192:195], v[64:67]
  v_add_u32 v17, 4294901760, v17
  ds_read_b64_tr_b16 v[48:49], v17 offset:0
  v_mfma_f32_16x16x32_bf16 v[68:71], v[32:35], v[196:199], v[68:71]
  ds_read_b64_tr_b16 v[50:51], v17 offset:2048
  v_mfma_f32_16x16x32_bf16 v[84:87], v[36:39], v[196:199], v[84:87]
  v_add_u32 v18, 4294901760, v18
  ds_read_b64_tr_b16 v[52:53], v18 offset:0
  v_mfma_f32_16x16x32_bf16 v[80:83], v[36:39], v[192:195], v[80:83]
  ds_read_b64_tr_b16 v[54:55], v18 offset:2048
  v_mfma_f32_16x16x32_bf16 v[96:99], v[40:43], v[192:195], v[96:99]
  v_add_u32 v19, 4294901760, v19
  ds_read_b64_tr_b16 v[56:57], v19 offset:0
  v_mfma_f32_16x16x32_bf16 v[100:103], v[40:43], v[196:199], v[100:103]
  ds_read_b64_tr_b16 v[58:59], v19 offset:2048
  v_mfma_f32_16x16x32_bf16 v[116:119], v[44:47], v[196:199], v[116:119]
  v_add_u32 v20, 4294901760, v20
  ds_read_b64_tr_b16 v[60:61], v20 offset:0
  v_mfma_f32_16x16x32_bf16 v[112:115], v[44:47], v[192:195], v[112:115]
  ds_read_b64_tr_b16 v[62:63], v20 offset:2048
  s_waitcnt vmcnt(12)
  v_mfma_f32_16x16x32_bf16 v[72:75], v[32:35], v[200:203], v[72:75]
  v_mfma_f32_16x16x32_bf16 v[76:79], v[32:35], v[204:207], v[76:79]
  v_mfma_f32_16x16x32_bf16 v[92:95], v[36:39], v[204:207], v[92:95]
  v_mfma_f32_16x16x32_bf16 v[88:91], v[36:39], v[200:203], v[88:91]
  v_mfma_f32_16x16x32_bf16 v[104:107], v[40:43], v[200:203], v[104:107]
  v_mfma_f32_16x16x32_bf16 v[108:111], v[40:43], v[204:207], v[108:111]
  v_mfma_f32_16x16x32_bf16 v[124:127], v[44:47], v[204:207], v[124:127]
  v_mfma_f32_16x16x32_bf16 v[120:123], v[44:47], v[200:203], v[120:123]
  s_waitcnt vmcnt(10)
  s_waitcnt lgkmcnt(0)
  v_mfma_f32_16x16x32_bf16 v[64:67], v[48:51], v[208:211], v[64:67]
  ds_read_b64_tr_b16 v[32:33], v17 offset:49152
  v_mfma_f32_16x16x32_bf16 v[68:71], v[48:51], v[212:215], v[68:71]
  ds_read_b64_tr_b16 v[34:35], v17 offset:51200
  v_mfma_f32_16x16x32_bf16 v[84:87], v[52:55], v[212:215], v[84:87]
  ds_read_b64_tr_b16 v[36:37], v18 offset:49152
  v_mfma_f32_16x16x32_bf16 v[80:83], v[52:55], v[208:211], v[80:83]
  ds_read_b64_tr_b16 v[38:39], v18 offset:51200
  v_mfma_f32_16x16x32_bf16 v[96:99], v[56:59], v[208:211], v[96:99]
  ds_read_b64_tr_b16 v[40:41], v19 offset:49152
  v_mfma_f32_16x16x32_bf16 v[100:103], v[56:59], v[212:215], v[100:103]
  ds_read_b64_tr_b16 v[42:43], v19 offset:51200
  v_mfma_f32_16x16x32_bf16 v[116:119], v[60:63], v[212:215], v[116:119]
  ds_read_b64_tr_b16 v[44:45], v20 offset:49152
  v_mfma_f32_16x16x32_bf16 v[112:115], v[60:63], v[208:211], v[112:115]
  ds_read_b64_tr_b16 v[46:47], v20 offset:51200
  s_waitcnt vmcnt(8)
  v_mfma_f32_16x16x32_bf16 v[72:75], v[48:51], v[216:219], v[72:75]
  v_mfma_f32_16x16x32_bf16 v[76:79], v[48:51], v[220:223], v[76:79]
  v_mfma_f32_16x16x32_bf16 v[92:95], v[52:55], v[220:223], v[92:95]
  v_mfma_f32_16x16x32_bf16 v[88:91], v[52:55], v[216:219], v[88:91]
  v_mfma_f32_16x16x32_bf16 v[104:107], v[56:59], v[216:219], v[104:107]
  v_mfma_f32_16x16x32_bf16 v[108:111], v[56:59], v[220:223], v[108:111]
  v_mfma_f32_16x16x32_bf16 v[124:127], v[60:63], v[220:223], v[124:127]
  v_mfma_f32_16x16x32_bf16 v[120:123], v[60:63], v[216:219], v[120:123]
  s_waitcnt vmcnt(6)
  s_waitcnt lgkmcnt(0)
  v_mfma_f32_16x16x32_bf16 v[64:67], v[32:35], v[224:227], v[64:67]
  ds_read_b64_tr_b16 v[48:49], v17 offset:16384
  v_mfma_f32_16x16x32_bf16 v[68:71], v[32:35], v[228:231], v[68:71]
  ds_read_b64_tr_b16 v[50:51], v17 offset:18432
  v_mfma_f32_16x16x32_bf16 v[84:87], v[36:39], v[228:231], v[84:87]
  ds_read_b64_tr_b16 v[52:53], v18 offset:16384
  v_mfma_f32_16x16x32_bf16 v[80:83], v[36:39], v[224:227], v[80:83]
  ds_read_b64_tr_b16 v[54:55], v18 offset:18432
  v_mfma_f32_16x16x32_bf16 v[96:99], v[40:43], v[224:227], v[96:99]
  ds_read_b64_tr_b16 v[56:57], v19 offset:16384
  v_mfma_f32_16x16x32_bf16 v[100:103], v[40:43], v[228:231], v[100:103]
  ds_read_b64_tr_b16 v[58:59], v19 offset:18432
  v_mfma_f32_16x16x32_bf16 v[116:119], v[44:47], v[228:231], v[116:119]
  ds_read_b64_tr_b16 v[60:61], v20 offset:16384
  v_mfma_f32_16x16x32_bf16 v[112:115], v[44:47], v[224:227], v[112:115]
  ds_read_b64_tr_b16 v[62:63], v20 offset:18432
  s_waitcnt vmcnt(2)
  s_waitcnt lgkmcnt(0)
  v_mfma_f32_16x16x32_bf16 v[64:67], v[48:51], v[240:243], v[64:67]
  v_mfma_f32_16x16x32_bf16 v[68:71], v[48:51], v[244:247], v[68:71]
  v_mfma_f32_16x16x32_bf16 v[84:87], v[52:55], v[244:247], v[84:87]
  v_mfma_f32_16x16x32_bf16 v[80:83], v[52:55], v[240:243], v[80:83]
  v_mfma_f32_16x16x32_bf16 v[96:99], v[56:59], v[240:243], v[96:99]
  v_mfma_f32_16x16x32_bf16 v[100:103], v[56:59], v[244:247], v[100:103]
  v_mfma_f32_16x16x32_bf16 v[116:119], v[60:63], v[244:247], v[116:119]
  v_mfma_f32_16x16x32_bf16 v[112:115], v[60:63], v[240:243], v[112:115]
  s_waitcnt vmcnt(0)
  v_mfma_f32_16x16x32_bf16 v[72:75], v[32:35], v[232:235], v[72:75]
  v_mfma_f32_16x16x32_bf16 v[76:79], v[32:35], v[236:239], v[76:79]
  ds_write_b128 v27, v[64:67] offset:0
  v_mfma_f32_16x16x32_bf16 v[92:95], v[36:39], v[236:239], v[92:95]
  v_mfma_f32_16x16x32_bf16 v[88:91], v[36:39], v[232:235], v[88:91]
  ds_write_b128 v27, v[68:71] offset:16384
  v_mfma_f32_16x16x32_bf16 v[104:107], v[40:43], v[232:235], v[104:107]
  v_mfma_f32_16x16x32_bf16 v[108:111], v[40:43], v[236:239], v[108:111]
  ds_write_b128 v28, v[80:83] offset:0
  v_mfma_f32_16x16x32_bf16 v[124:127], v[44:47], v[236:239], v[124:127]
  v_mfma_f32_16x16x32_bf16 v[120:123], v[44:47], v[232:235], v[120:123]
  ds_write_b128 v28, v[84:87] offset:16384
  v_mfma_f32_16x16x32_bf16 v[72:75], v[48:51], v[248:251], v[72:75]
  v_mfma_f32_16x16x32_bf16 v[76:79], v[48:51], v[252:255], v[76:79]
  ds_write_b128 v27, v[96:99] offset:128
  v_mfma_f32_16x16x32_bf16 v[92:95], v[52:55], v[252:255], v[92:95]
  v_mfma_f32_16x16x32_bf16 v[88:91], v[52:55], v[248:251], v[88:91]
  ds_write_b128 v27, v[100:103] offset:16512
  v_mfma_f32_16x16x32_bf16 v[104:107], v[56:59], v[248:251], v[104:107]
  v_mfma_f32_16x16x32_bf16 v[108:111], v[56:59], v[252:255], v[108:111]
  ds_write_b128 v28, v[112:115] offset:128
  v_mfma_f32_16x16x32_bf16 v[124:127], v[60:63], v[252:255], v[124:127]
  v_mfma_f32_16x16x32_bf16 v[120:123], v[60:63], v[248:251], v[120:123]
  ds_write_b128 v28, v[116:119] offset:16512
  ds_write_b128 v27, v[72:75] offset:32768
  ds_write_b128 v27, v[76:79] offset:49152
  ds_write_b128 v28, v[88:91] offset:32768
  ds_write_b128 v28, v[92:95] offset:49152
  ds_write_b128 v27, v[104:107] offset:32896
  ds_write_b128 v27, v[108:111] offset:49280
  s_nop 0
  ds_write_b128 v28, v[120:123] offset:32896
  ds_write_b128 v28, v[124:127] offset:49280
L_final:
  v_lshrrev_b32 v17, 3, v0
  v_and_b32 v16, 7, v0
  s_lshr_b32 s99, s3, 1
  s_and_b32 s10, s3, 1
  s_lshl3_add_u32 s99, s99, s10
  s_lshl_b32 s99, s99, 11
  s_add_u32 s99, s99, 81920
  v_lshlrev_b32 v22, 1, v16
  v_xor_b32 v22, v22, v17
  v_lshl_add_u32 v22, v22, 4, s99
  v_lshl_add_u32 v22, v17, 8, v22
  v_xor_b32 v23, 16, v22
  v_xor_b32 v24, s3, v16
  s_lshl_b32 s99, s3, 10
  s_add_u32 s99, s99, 52224
  v_lshl_add_u32 v24, v24, 4, s99
  v_lshl_add_u32 v24, v17, 7, v24
  s_lshl_b32 s99, s3, 5
  s_add_u32 s99, s99, 51200
  v_lshl_add_u32 v25, v17, 2, s99
  v_and_b32 v26, 3, v17
  v_lshrrev_b32 v18, 2, v17
  v_lshl_add_u32 v26, v26, 6, v18
  v_mul_u32_u24 v26, 896, v26
  v_lshl_add_u32 v26, v16, 4, v26
  s_lshl4_add_u32 s99, s4, s6
  s_lshl3_add_u32 s99, s99, s3
  s_mul_i32 s99, s99, 14
  s_add_u32 s99, s99, s7
  s_lshl_b32 s99, s99, 7
  s_waitcnt lgkmcnt(0)
  s_barrier
  ds_read_b128 v[32:35], v22 offset:0
  ds_read_b128 v[36:39], v23 offset:0
  ds_read_b128 v[40:43], v22 offset:4096
  ds_read_b128 v[44:47], v23 offset:4096
  ds_read_b128 v[48:51], v22 offset:8192
  ds_read_b128 v[52:55], v23 offset:8192
  ds_read_b128 v[56:59], v22 offset:12288
  ds_read_b128 v[60:63], v23 offset:12288
  ds_read_b128 v[64:67], v24
  ds_read_b32 v68, v25
  s_waitcnt lgkmcnt(6)
  v_pk_add_f32 v[32:33], v[32:33], v[40:41]
  v_pk_add_f32 v[34:35], v[34:35], v[42:43]
  v_pk_add_f32 v[36:37], v[36:37], v[44:45]
  v_pk_add_f32 v[38:39], v[38:39], v[46:47]
  s_waitcnt lgkmcnt(2)
  v_pk_add_f32 v[48:49], v[48:49], v[56:57]
  v_pk_add_f32 v[50:51], v[50:51], v[58:59]
  v_pk_add_f32 v[52:53], v[52:53], v[60:61]
  v_pk_add_f32 v[54:55], v[54:55], v[62:63]
  v_pk_add_f32 v[32:33], v[32:33], v[48:49]
  v_pk_add_f32 v[34:35], v[34:35], v[50:51]
  v_pk_add_f32 v[36:37], v[36:37], v[52:53]
  v_pk_add_f32 v[38:39], v[38:39], v[54:55]
  s_waitcnt lgkmcnt(0)
  v_lshlrev_b32 v40, 16, v64
  v_and_b32 v41, 0xffff0000, v64
  v_lshlrev_b32 v42, 16, v65
  v_and_b32 v43, 0xffff0000, v65
  v_lshlrev_b32 v44, 16, v66
  v_and_b32 v45, 0xffff0000, v66
  v_lshlrev_b32 v46, 16, v67
  v_and_b32 v47, 0xffff0000, v67
  v_pk_add_f32 v[40:41], v[40:41], v[32:33] neg_lo:[0,1] neg_hi:[0,1]
  v_pk_add_f32 v[42:43], v[42:43], v[34:35] neg_lo:[0,1] neg_hi:[0,1]
  v_pk_add_f32 v[44:45], v[44:45], v[36:37] neg_lo:[0,1] neg_hi:[0,1]
  v_pk_add_f32 v[46:47], v[46:47], v[38:39] neg_lo:[0,1] neg_hi:[0,1]
  v_pk_fma_f32 v[32:33], v[40:41], v[68:69], v[32:33] op_sel:[0,0,0] op_sel_hi:[1,0,1]
  v_pk_fma_f32 v[34:35], v[42:43], v[68:69], v[34:35] op_sel:[0,0,0] op_sel_hi:[1,0,1]
  v_pk_fma_f32 v[36:37], v[44:45], v[68:69], v[36:37] op_sel:[0,0,0] op_sel_hi:[1,0,1]
  v_pk_fma_f32 v[38:39], v[46:47], v[68:69], v[38:39] op_sel:[0,0,0] op_sel_hi:[1,0,1]
  v_cvt_pk_bf16_f32 v48, v32, v33
  v_cvt_pk_bf16_f32 v49, v34, v35
  v_cvt_pk_bf16_f32 v50, v36, v37
  v_cvt_pk_bf16_f32 v51, v38, v39
  buffer_store_dwordx4 v[48:51], v26, s[72:75], s99 offen sc1
L_exit:
  s_endpgm
L_P2:
  v_mfma_f32_16x16x32_bf16 v[64:67], v[128:131], v[144:147], v[64:67]
  v_mfma_f32_16x16x32_bf16 v[80:83], v[132:135], v[144:147], v[80:83]
  v_mfma_f32_16x16x32_bf16 v[96:99], v[136:139], v[144:147], v[96:99]
  v_mfma_f32_16x16x32_bf16 v[112:115], v[140:143], v[144:147], v[112:115]
  v_mfma_f32_16x16x32_bf16 v[68:71], v[128:131], v[148:151], v[68:71]
  v_mfma_f32_16x16x32_bf16 v[84:87], v[132:135], v[148:151], v[84:87]
  v_mfma_f32_16x16x32_bf16 v[100:103], v[136:139], v[148:151], v[100:103]
  v_mfma_f32_16x16x32_bf16 v[116:119], v[140:143], v[148:151], v[116:119]
  v_mfma_f32_16x16x32_bf16 v[72:75], v[128:131], v[152:155], v[72:75]
  v_mfma_f32_16x16x32_bf16 v[88:91], v[132:135], v[152:155], v[88:91]
  v_mfma_f32_16x16x32_bf16 v[104:107], v[136:139], v[152:155], v[104:107]
  v_mfma_f32_16x16x32_bf16 v[120:123], v[140:143], v[152:155], v[120:123]
  v_mfma_f32_16x16x32_bf16 v[76:79], v[128:131], v[156:159], v[76:79]
  v_mfma_f32_16x16x32_bf16 v[92:95], v[132:135], v[156:159], v[92:95]
  v_mfma_f32_16x16x32_bf16 v[108:111], v[136:139], v[156:159], v[108:111]
  v_mfma_f32_16x16x32_bf16 v[124:127], v[140:143], v[156:159], v[124:127]
  s_setprio 3
  global_load_dword v12, v11, s[46:47] sc1
  v_mul_f32 v32, s87, v64
  v_mul_f32 v33, s87, v65
  v_mul_f32 v34, s87, v66
  v_mul_f32 v35, s87, v67
  v_exp_f32 v32, v32
  v_exp_f32 v33, v33
  v_exp_f32 v34, v34
  v_exp_f32 v35, v35
  v_add_f32 v32, 1.0, v32
  v_add_f32 v33, 1.0, v33
  v_add_f32 v34, 1.0, v34
  v_add_f32 v35, 1.0, v35
  v_rcp_f32 v32, v32
  v_rcp_f32 v33, v33
  v_rcp_f32 v34, v34
  v_rcp_f32 v35, v35
  v_mul_f32 v32, v32, v96
  v_mul_f32 v33, v33, v97
  v_mul_f32 v34, v34, v98
  v_mul_f32 v35, v35, v99
  v_cvt_pk_bf16_f32 v40, v32, v33
  v_cvt_pk_bf16_f32 v41, v34, v35
  v_mul_f32 v36, s87, v80
  v_mul_f32 v37, s87, v81
  v_mul_f32 v38, s87, v82
  v_mul_f32 v39, s87, v83
  v_exp_f32 v36, v36
  v_exp_f32 v37, v37
  v_exp_f32 v38, v38
  v_exp_f32 v39, v39
  v_add_f32 v36, 1.0, v36
  v_add_f32 v37, 1.0, v37
  v_add_f32 v38, 1.0, v38
  v_add_f32 v39, 1.0, v39
  v_rcp_f32 v36, v36
  v_rcp_f32 v37, v37
  v_rcp_f32 v38, v38
  v_rcp_f32 v39, v39
  v_mul_f32 v36, v36, v112
  v_mul_f32 v37, v37, v113
  v_mul_f32 v38, v38, v114
  v_mul_f32 v39, v39, v115
  v_cvt_pk_bf16_f32 v42, v36, v37
  v_cvt_pk_bf16_f32 v43, v38, v39
  buffer_store_dwordx4 v[40:43], v6, s[68:71], s96 offen offset:0 sc1
  s_lshr_b32 s81, s8, 1
  s_mul_i32 s81, s81, 4608
  s_and_b32 s9, s8, 1
  s_lshl_b32 s9, s9, 11
  s_add_u32 s81, s81, s9
  s_waitcnt vmcnt(2) lgkmcnt(0)
  s_barrier
  s_add_u32 m0, s15, 0
  s_bfe_u32 s78, s82, 0x40000
  s_mul_i32 s78, s78, 114688
  buffer_load_dwordx4 v9, s[64:67], s78 offen lds
  v_mul_f32 v32, s87, v68
  v_mul_f32 v33, s87, v69
  v_mul_f32 v34, s87, v70
  v_mul_f32 v35, s87, v71
  v_exp_f32 v32, v32
  v_exp_f32 v33, v33
  v_exp_f32 v34, v34
  v_exp_f32 v35, v35
  v_add_f32 v32, 1.0, v32
  v_add_f32 v33, 1.0, v33
  s_add_u32 m0, s15, 1024
  s_add_u32 s78, s78, 7168
  buffer_load_dwordx4 v9, s[64:67], s78 offen lds
  v_add_f32 v34, 1.0, v34
  v_add_f32 v35, 1.0, v35
  v_rcp_f32 v32, v32
  v_rcp_f32 v33, v33
  v_rcp_f32 v34, v34
  v_rcp_f32 v35, v35
  v_mul_f32 v32, v32, v100
  v_mul_f32 v33, v33, v101
  v_mul_f32 v34, v34, v102
  v_mul_f32 v35, v35, v103
  s_add_u32 m0, s15, 2048
  s_add_u32 s78, s78, 7168
  buffer_load_dwordx4 v9, s[64:67], s78 offen lds
  v_cvt_pk_bf16_f32 v44, v32, v33
  v_cvt_pk_bf16_f32 v45, v34, v35
  v_mul_f32 v36, s87, v84
  v_mul_f32 v37, s87, v85
  v_mul_f32 v38, s87, v86
  v_mul_f32 v39, s87, v87
  v_exp_f32 v36, v36
  v_exp_f32 v37, v37
  v_exp_f32 v38, v38
  v_exp_f32 v39, v39
  s_add_u32 m0, s15, 3072
  s_add_u32 s78, s78, 7168
  buffer_load_dwordx4 v9, s[64:67], s78 offen lds
  v_add_f32 v36, 1.0, v36
  v_add_f32 v37, 1.0, v37
  v_add_f32 v38, 1.0, v38
  v_add_f32 v39, 1.0, v39
  v_rcp_f32 v36, v36
  v_rcp_f32 v37, v37
  v_rcp_f32 v38, v38
  v_rcp_f32 v39, v39
  v_mul_f32 v36, v36, v116
  v_mul_f32 v37, v37, v117
  v_mul_f32 v38, v38, v118
  v_mul_f32 v39, v39, v119
  v_cvt_pk_bf16_f32 v46, v36, v37
  v_cvt_pk_bf16_f32 v47, v38, v39
  buffer_store_dwordx4 v[44:47], v6, s[68:71], s96 offen offset:1024 sc1
  s_waitcnt vmcnt(7) lgkmcnt(0)
  s_barrier
  s_add_u32 m0, s15, 16384
  s_bfe_u32 s78, s82, 0x40004
  s_mul_i32 s78, s78, 114688
  buffer_load_dwordx4 v9, s[64:67], s78 offen lds
  v_mul_f32 v32, s87, v72
  v_mul_f32 v33, s87, v73
  v_mul_f32 v34, s87, v74
  v_mul_f32 v35, s87, v75
  v_exp_f32 v32, v32
  v_exp_f32 v33, v33
  v_exp_f32 v34, v34
  v_exp_f32 v35, v35
  v_add_f32 v32, 1.0, v32
  v_add_f32 v33, 1.0, v33
  s_add_u32 m0, s15, 17408
  s_add_u32 s78, s78, 7168
  buffer_load_dwordx4 v9, s[64:67], s78 offen lds
  v_add_f32 v34, 1.0, v34
  v_add_f32 v35, 1.0, v35
  v_rcp_f32 v32, v32
  v_rcp_f32 v33, v33
  v_rcp_f32 v34, v34
  v_rcp_f32 v35, v35
  v_mul_f32 v32, v32, v104
  v_mul_f32 v33, v33, v105
  v_mul_f32 v34, v34, v106
  v_mul_f32 v35, v35, v107
  s_add_u32 m0, s15, 18432
  s_add_u32 s78, s78, 7168
  buffer_load_dwordx4 v9, s[64:67], s78 offen lds
  v_cvt_pk_bf16_f32 v40, v32, v33
  v_cvt_pk_bf16_f32 v41, v34, v35
  v_mul_f32 v36, s87, v88
  v_mul_f32 v37, s87, v89
  v_mul_f32 v38, s87, v90
  v_mul_f32 v39, s87, v91
  v_exp_f32 v36, v36
  v_exp_f32 v37, v37
  v_exp_f32 v38, v38
  v_exp_f32 v39, v39
  s_add_u32 m0, s15, 19456
  s_add_u32 s78, s78, 7168
  buffer_load_dwordx4 v9, s[64:67], s78 offen lds
  v_add_f32 v36, 1.0, v36
  v_add_f32 v37, 1.0, v37
  v_add_f32 v38, 1.0, v38
  v_add_f32 v39, 1.0, v39
  v_rcp_f32 v36, v36
  v_rcp_f32 v37, v37
  v_rcp_f32 v38, v38
  v_rcp_f32 v39, v39
  v_mul_f32 v36, v36, v120
  v_mul_f32 v37, v37, v121
  v_mul_f32 v38, v38, v122
  v_mul_f32 v39, v39, v123
  v_cvt_pk_bf16_f32 v42, v36, v37
  v_cvt_pk_bf16_f32 v43, v38, v39
  buffer_store_dwordx4 v[40:43], v6, s[68:71], s96 offen offset:2048 sc1
  s_waitcnt vmcnt(12) lgkmcnt(0)
  s_barrier
  s_waitcnt vmcnt(11)
  v_readfirstlane_b32 s50, v12
  s_nop 1
  s_cmp_lg_u32 s50, 0
  s_cbranch_scc1 L_nonok_12
  s_mov_b32 s13, 131072
L_spin_13:
  global_load_dword v12, v11, s[46:47] sc1
  s_waitcnt vmcnt(0)
  v_readfirstlane_b32 s50, v12
  s_nop 1
  s_cmp_lg_u32 s50, 0
  s_cbranch_scc1 L_spinend_14
  s_sub_u32 s13, s13, 1
  s_cbranch_scc0 L_spin_13
L_spinend_14:
L_nonok_12:
  v_mul_f32 v32, s87, v76
  v_mul_f32 v33, s87, v77
  v_mul_f32 v34, s87, v78
  v_mul_f32 v35, s87, v79
  v_exp_f32 v32, v32
  v_exp_f32 v33, v33
  v_exp_f32 v34, v34
  v_exp_f32 v35, v35
  v_add_f32 v32, 1.0, v32
  v_add_f32 v33, 1.0, v33
  v_add_f32 v34, 1.0, v34
  v_add_f32 v35, 1.0, v35
  v_rcp_f32 v32, v32
  v_rcp_f32 v33, v33
  v_rcp_f32 v34, v34
  v_rcp_f32 v35, v35
  v_mul_f32 v32, v32, v108
  v_mul_f32 v33, v33, v109
  v_mul_f32 v34, v34, v110
  v_mul_f32 v35, v35, v111
  v_cvt_pk_bf16_f32 v44, v32, v33
  v_cvt_pk_bf16_f32 v45, v34, v35
  v_mul_f32 v36, s87, v92
  v_mul_f32 v37, s87, v93
  v_mul_f32 v38, s87, v94
  v_mul_f32 v39, s87, v95
  v_exp_f32 v36, v36
  v_exp_f32 v37, v37
  v_exp_f32 v38, v38
  v_exp_f32 v39, v39
  v_add_f32 v36, 1.0, v36
  v_add_f32 v37, 1.0, v37
  v_add_f32 v38, 1.0, v38
  v_add_f32 v39, 1.0, v39
  v_rcp_f32 v36, v36
  v_rcp_f32 v37, v37
  v_rcp_f32 v38, v38
  v_rcp_f32 v39, v39
  v_mul_f32 v36, v36, v124
  v_mul_f32 v37, v37, v125
  v_mul_f32 v38, v38, v126
  v_mul_f32 v39, v39, v127
  v_cvt_pk_bf16_f32 v46, v36, v37
  v_cvt_pk_bf16_f32 v47, v38, v39
  buffer_store_dwordx4 v[44:47], v6, s[68:71], s96 offen offset:3072 sc1
  v_lshrrev_b32 v56, 3, v0
  v_and_b32 v57, 7, v0
  v_lshrrev_b32 v60, 5, v0
  s_lshl_b32 s9, s8, 6
  s_add_u32 s9, s9, 41984
  v_lshl_add_u32 v19, v0, 3, s9
  s_lshl_b32 s9, s8, 11
  s_add_u32 s9, s9, 4096
  v_lshl_add_u32 v23, v57, 8, s9
  buffer_load_dword v28, v23, s[68:71], 0 offen sc1
  s_waitcnt vmcnt(13) lgkmcnt(0)
  s_barrier
  s_lshr_b32 s9, s8, 1
  s_lshl1_add_u32 s9, s86, s9
  s_and_b32 s10, s9, 7
  v_xor_b32 v58, s10, v57
  v_mul_u32_u24 v24, 57344, v56
  v_lshl_add_u32 v24, v58, 4, v24
  s_and_b32 s10, s8, 1
  s_mul_i32 s10, s10, 917504
  s_lshl_b32 s9, s9, 7
  s_add_u32 s9, s9, s10
  s_add_u32 s9, s9, 1048576
  v_add_u32 v24, s9, v24
  v_and_b32 v58, 3, v0
  v_bfe_u32 v61, v0, 2, 3
  v_add3_u32 v61, v61, v60, 1
  v_lshrrev_b32 v59, 1, v61
  v_and_b32 v61, 1, v61
  v_lshl_add_u32 v61, v58, 1, v61
  v_lshl_add_u32 v59, v59, 3, v61
  s_mul_i32 s12, s88, 4608
  s_add_u32 s9, s12, 32768
  v_lshl_add_u32 v25, v59, 4, s9
  v_bfe_u32 v59, v0, 4, 1
  v_lshl_add_u32 v59, v59, 2, v58
  v_bfe_u32 v61, v0, 2, 2
  v_lshl_add_u32 v61, v60, 3, v61
  v_sub_u32 v59, v59, v61
  s_add_u32 s9, s12, 42528
  v_lshl_add_u32 v26, v59, 3, s9
  v_lshrrev_b32 v59, 2, v0
  v_lshl_add_u32 v58, v58, 6, v59
  s_lshl4_add_u32 s9, s4, s6
  s_lshl_b32 s9, s9, 6
  s_add_u32 s9, s9, 16384
  v_lshl_add_u32 v27, v58, 2, s9
  s_mul_i32 s9, s8, 4608
  s_add_u32 m0, s9, 32768
  v_mov_b32 v15, 16777216
  s_mov_b32 exec_hi, 0
  buffer_load_dwordx4 v15, s[68:71], 0 offen lds
  s_mov_b32 exec_hi, -1
  s_waitcnt vmcnt(1)
  v_cmp_ne_u32 vcc, s50, v28
  s_cbranch_vccz L_ok_15
  s_mov_b32 s13, 131072
L_spin_16:
  buffer_load_dword v28, v23, s[68:71], 0 offen offset:0 sc1
  s_waitcnt vmcnt(0)
  v_cmp_ne_u32 vcc, s50, v28
  s_cbranch_vccz L_spinend_17
  s_sub_u32 s13, s13, 1
  s_cbranch_scc0 L_spin_16
L_spinend_17:
L_ok_15:
  s_waitcnt vmcnt(1) lgkmcnt(0)
  s_barrier
  s_mov_b32 exec_hi, 0
  buffer_store_dword v12, v7, s[68:71], s97 offen sc1
  s_mov_b32 exec_hi, -1
  s_add_u32 m0, s81, 33280
  s_nop 0
  buffer_load_dwordx4 v24, s[68:71], 0 offen sc1 lds
  s_add_u32 m0, s81, 34304
  s_mov_b32 s10, 458752
  buffer_load_dwordx4 v24, s[68:71], s10 offen sc1 lds
  s_add_u32 m0, s15, 147456
  s_bfe_u32 s78, s82, 0x40008
  s_mul_i32 s78, s78, 114688
  buffer_load_dwordx4 v9, s[64:67], s78 offen lds
  s_add_u32 m0, s15, 148480
  s_add_u32 s78, s78, 7168
  buffer_load_dwordx4 v9, s[64:67], s78 offen lds
  s_add_u32 m0, s15, 149504
  s_add_u32 s78, s78, 7168
  buffer_load_dwordx4 v9, s[64:67], s78 offen lds
  s_add_u32 m0, s15, 150528
  s_add_u32 s78, s78, 7168
  buffer_load_dwordx4 v9, s[64:67], s78 offen lds
  s_waitcnt vmcnt(7) lgkmcnt(0)
  s_barrier
  s_add_u32 m0, s15, 65536
  s_bfe_u32 s78, s82, 0x4000c
  s_mul_i32 s78, s78, 114688
  buffer_load_dwordx4 v9, s[64:67], s78 offen lds
  s_add_u32 m0, s15, 66560
  s_add_u32 s78, s78, 7168
  buffer_load_dwordx4 v9, s[64:67], s78 offen lds
  s_add_u32 m0, s15, 67584
  s_add_u32 s78, s78, 7168
  buffer_load_dwordx4 v9, s[64:67], s78 offen lds
  s_add_u32 m0, s15, 68608
  s_add_u32 s78, s78, 7168
  buffer_load_dwordx4 v9, s[64:67], s78 offen lds
  s_add_u32 m0, s15, 114688
  s_bfe_u32 s78, s82, 0x40010
  s_mul_i32 s78, s78, 114688
  buffer_load_dwordx4 v9, s[64:67], s78 offen lds
  s_waitcnt vmcnt(11)
  s_add_u32 m0, s15, 115712
  s_add_u32 s78, s78, 7168
  buffer_load_dwordx4 v9, s[64:67], s78 offen lds
  s_waitcnt vmcnt(11)
  s_add_u32 m0, s15, 116736
  s_add_u32 s78, s78, 7168
  buffer_load_dwordx4 v9, s[64:67], s78 offen lds
  s_waitcnt vmcnt(11)
  s_add_u32 m0, s15, 117760
  s_add_u32 s78, s78, 7168
  buffer_load_dwordx4 v9, s[64:67], s78 offen lds
  s_waitcnt vmcnt(11)
  s_add_u32 m0, s15, 81920
  s_bfe_u32 s78, s82, 0x40014
  s_mul_i32 s78, s78, 114688
  buffer_load_dwordx4 v9, s[64:67], s78 offen lds
  s_waitcnt vmcnt(11)
  s_add_u32 m0, s15, 82944
  s_add_u32 s78, s78, 7168
  buffer_load_dwordx4 v9, s[64:67], s78 offen lds
  s_waitcnt vmcnt(11)
  s_add_u32 m0, s15, 83968
  s_add_u32 s78, s78, 7168
  buffer_load_dwordx4 v9, s[64:67], s78 offen lds
  s_waitcnt vmcnt(11)
  s_add_u32 m0, s15, 84992
  s_add_u32 s78, s78, 7168
  buffer_load_dwordx4 v9, s[64:67], s78 offen lds
  s_mov_b64 exec, 1
  ds_add_u32 v13, v14
  s_mov_b64 exec, -1
  v_mov_b32 v60, 0
  v_mov_b32 v61, 0
  s_mov_b32 s13, 1048576
L_spin_18:
  ds_read_b32 v15, v13 offset:0
  s_waitcnt lgkmcnt(0)
  v_readfirstlane_b32 s9, v15
  s_nop 1
  s_cmp_ge_u32 s9, 8
  s_cbranch_scc1 L_spinend_19
  s_sub_u32 s13, s13, 1
  s_cbranch_scc0 L_spin_18
L_spinend_19:
  s_bitcmp1_b32 s3, 0
  s_cbranch_scc1 L_conv1
  ds_read_b128 v[128:131], v25 offset:384
  ds_read_b64_tr_b16 v[192:193], v26 offset:32
  ds_read_b64_tr_b16 v[194:195], v26 offset:0
  ds_read_b128 v[132:135], v25 offset:896
  ds_read_b64_tr_b16 v[196:197], v26 offset:544
  ds_read_b64_tr_b16 v[198:199], v26 offset:512
  ds_read_b128 v[136:139], v25 offset:1408
  ds_read_b64_tr_b16 v[200:201], v26 offset:1056
  ds_read_b64_tr_b16 v[202:203], v26 offset:1024
  ds_read_b128 v[140:143], v25 offset:1920
  ds_read_b64_tr_b16 v[204:205], v26 offset:1568
  ds_read_b64_tr_b16 v[206:207], v26 offset:1536
  ds_read_b128 v[144:147], v25 offset:2432
  ds_read_b64_tr_b16 v[208:209], v26 offset:2080
  ds_read_b64_tr_b16 v[210:211], v26 offset:2048
  ds_read_b128 v[148:151], v25 offset:2944
  ds_read_b64_tr_b16 v[212:213], v26 offset:2592
  ds_read_b64_tr_b16 v[214:215], v26 offset:2560
  ds_read_b128 v[152:155], v25 offset:3456
  ds_read_b64_tr_b16 v[216:217], v26 offset:3104
  ds_read_b64_tr_b16 v[218:219], v26 offset:3072
  ds_read_b128 v[156:159], v25 offset:3968
  ds_read_b64_tr_b16 v[220:221], v26 offset:3616
  ds_read_b64_tr_b16 v[222:223], v26 offset:3584
  s_setprio 3
  s_add_u32 m0, s15, 98304
  s_bfe_u32 s78, s82, 0x40018
  s_mul_i32 s78, s78, 114688
  buffer_load_dwordx4 v9, s[64:67], s78 offen lds
  s_add_u32 m0, s15, 99328
  s_add_u32 s78, s78, 7168
  buffer_load_dwordx4 v9, s[64:67], s78 offen lds
  s_add_u32 m0, s15, 100352
  s_add_u32 s78, s78, 7168
  buffer_load_dwordx4 v9, s[64:67], s78 offen lds
  s_add_u32 m0, s15, 101376
  s_add_u32 s78, s78, 7168
  buffer_load_dwordx4 v9, s[64:67], s78 offen lds
  s_setprio 3
  s_waitcnt lgkmcnt(0)
  v_mfma_f32_32x32x16_bf16 v[64:79], v[128:131], v[192:195], 0
  ds_read_b128 v[160:163], v25 offset:256
  ds_read_b64_tr_b16 v[224:225], v26 offset:160
  v_mfma_f32_32x32x16_bf16 v[80:95], v[136:139], v[196:199], 0
  ds_read_b64_tr_b16 v[226:227], v26 offset:128
  ds_read_b128 v[164:167], v25 offset:768
  v_mfma_f32_32x32x16_bf16 v[80:95], v[132:135], v[200:203], v[80:95]
  ds_read_b64_tr_b16 v[228:229], v26 offset:672
  ds_read_b64_tr_b16 v[230:231], v26 offset:640
  v_mfma_f32_32x32x16_bf16 v[96:111], v[136:139], v[200:203], 0
  ds_read_b128 v[168:171], v25 offset:1280
  ds_read_b64_tr_b16 v[232:233], v26 offset:1184
  v_mfma_f32_32x32x16_bf16 v[80:95], v[140:143], v[192:195], v[80:95]
  ds_read_b64_tr_b16 v[234:235], v26 offset:1152
  ds_read_b128 v[172:175], v25 offset:1792
  v_mfma_f32_32x32x16_bf16 v[80:95], v[128:131], v[204:207], v[80:95]
  ds_read_b64_tr_b16 v[236:237], v26 offset:1696
  ds_read_b64_tr_b16 v[238:239], v26 offset:1664
  v_mfma_f32_32x32x16_bf16 v[96:111], v[140:143], v[196:199], v[96:111]
  ds_read_b128 v[176:179], v25 offset:2304
  ds_read_b64_tr_b16 v[240:241], v26 offset:2208
  v_mfma_f32_32x32x16_bf16 v[96:111], v[132:135], v[204:207], v[96:111]
  ds_read_b64_tr_b16 v[242:243], v26 offset:2176
  ds_read_b128 v[180:183], v25 offset:2816
  v_mfma_f32_32x32x16_bf16 v[96:111], v[144:147], v[192:195], v[96:111]
  ds_read_b64_tr_b16 v[244:245], v26 offset:2720
  ds_read_b64_tr_b16 v[246:247], v26 offset:2688
  v_mfma_f32_32x32x16_bf16 v[96:111], v[128:131], v[208:211], v[96:111]
  ds_read_b128 v[184:187], v25 offset:3328
  ds_read_b64_tr_b16 v[248:249], v26 offset:3232
  v_mfma_f32_32x32x16_bf16 v[112:127], v[144:147], v[204:207], 0
  ds_read_b64_tr_b16 v[250:251], v26 offset:3200
  ds_read_b128 v[188:191], v25 offset:3840
  v_mfma_f32_32x32x16_bf16 v[112:127], v[140:143], v[208:211], v[112:127]
  ds_read_b64_tr_b16 v[252:253], v26 offset:3744
  ds_read_b64_tr_b16 v[254:255], v26 offset:3712
  v_mfma_f32_32x32x16_bf16 v[112:127], v[148:151], v[200:203], v[112:127]
  v_mfma_f32_32x32x16_bf16 v[112:127], v[136:139], v[212:215], v[112:127]
  v_mfma_f32_32x32x16_bf16 v[112:127], v[152:155], v[196:199], v[112:127]
  v_mfma_f32_32x32x16_bf16 v[112:127], v[132:135], v[216:219], v[112:127]
  v_mfma_f32_32x32x16_bf16 v[112:127], v[156:159], v[192:195], v[112:127]
  v_mfma_f32_32x32x16_bf16 v[112:127], v[128:131], v[220:223], v[112:127]
  s_waitcnt lgkmcnt(0)
  s_waitcnt vmcnt(0)
  s_mov_b64 exec, 1
  ds_add_u32 v13, v14 offset:4
  s_mov_b64 exec, -1
  v_mfma_f32_32x32x16_bf16 v[64:79], v[160:163], v[224:227], v[64:79]
  ds_read_b128 v[128:131], v25 offset:128
  ds_read_b64_tr_b16 v[192:193], v26 offset:288
  v_mfma_f32_32x32x16_bf16 v[80:95], v[168:171], v[228:231], v[80:95]
  ds_read_b64_tr_b16 v[194:195], v26 offset:256
  ds_read_b128 v[132:135], v25 offset:640
  v_mfma_f32_32x32x16_bf16 v[80:95], v[164:167], v[232:235], v[80:95]
  ds_read_b64_tr_b16 v[196:197], v26 offset:800
  ds_read_b64_tr_b16 v[198:199], v26 offset:768
  v_mfma_f32_32x32x16_bf16 v[96:111], v[168:171], v[232:235], v[96:111]
  ds_read_b128 v[136:139], v25 offset:1152
  ds_read_b64_tr_b16 v[200:201], v26 offset:1312
  v_mfma_f32_32x32x16_bf16 v[80:95], v[172:175], v[224:227], v[80:95]
  ds_read_b64_tr_b16 v[202:203], v26 offset:1280
  ds_read_b128 v[140:143], v25 offset:1664
  v_mfma_f32_32x32x16_bf16 v[80:95], v[160:163], v[236:239], v[80:95]
  ds_read_b64_tr_b16 v[204:205], v26 offset:1824
  ds_read_b64_tr_b16 v[206:207], v26 offset:1792
  v_mfma_f32_32x32x16_bf16 v[96:111], v[172:175], v[228:231], v[96:111]
  ds_read_b128 v[144:147], v25 offset:2176
  ds_read_b64_tr_b16 v[208:209], v26 offset:2336
  v_mfma_f32_32x32x16_bf16 v[96:111], v[164:167], v[236:239], v[96:111]
  ds_read_b64_tr_b16 v[210:211], v26 offset:2304
  ds_read_b128 v[148:151], v25 offset:2688
  v_mfma_f32_32x32x16_bf16 v[96:111], v[176:179], v[224:227], v[96:111]
  ds_read_b64_tr_b16 v[212:213], v26 offset:2848
  ds_read_b64_tr_b16 v[214:215], v26 offset:2816
  v_mfma_f32_32x32x16_bf16 v[96:111], v[160:163], v[240:243], v[96:111]
  ds_read_b128 v[152:155], v25 offset:3200
  ds_read_b64_tr_b16 v[216:217], v26 offset:3360
  v_mfma_f32_32x32x16_bf16 v[112:127], v[176:179], v[236:239], v[112:127]
  ds_read_b64_tr_b16 v[218:219], v26 offset:3328
  ds_read_b128 v[156:159], v25 offset:3712
  v_mfma_f32_32x32x16_bf16 v[112:127], v[172:175], v[240:243], v[112:127]
  ds_read_b64_tr_b16 v[220:221], v26 offset:3872
  ds_read_b64_tr_b16 v[222:223], v26 offset:3840
  v_mfma_f32_32x32x16_bf16 v[112:127], v[180:183], v[232:235], v[112:127]
  v_mfma_f32_32x32x16_bf16 v[112:127], v[168:171], v[244:247], v[112:127]
  v_mfma_f32_32x32x16_bf16 v[112:127], v[184:187], v[228:231], v[112:127]
  v_mfma_f32_32x32x16_bf16 v[112:127], v[164:167], v[248:251], v[112:127]
  v_mfma_f32_32x32x16_bf16 v[112:127], v[188:191], v[224:227], v[112:127]
  v_mfma_f32_32x32x16_bf16 v[112:127], v[160:163], v[252:255], v[112:127]
  s_lshl1_add_u32 s10, s86, s88
  s_lshl_b32 s10, s10, 9
  v_lshlrev_b32 v59, 3, v0
  v_xor_b32 v61, 64, v19
  s_waitcnt lgkmcnt(0)
  v_mfma_f32_32x32x16_bf16 v[64:79], v[128:131], v[192:195], v[64:79]
  ds_read_b128 v[160:163], v25 offset:0
  ds_read_b64_tr_b16 v[224:225], v26 offset:416
  ds_read_b64_tr_b16 v[226:227], v26 offset:384
  v_mfma_f32_32x32x16_bf16 v[80:95], v[136:139], v[196:199], v[80:95]
  ds_read_b128 v[164:167], v25 offset:512
  ds_read_b64_tr_b16 v[228:229], v26 offset:928
  ds_read_b64_tr_b16 v[230:231], v26 offset:896
  v_mfma_f32_32x32x16_bf16 v[80:95], v[132:135], v[200:203], v[80:95]
  ds_read_b128 v[168:171], v25 offset:1024
  ds_read_b64_tr_b16 v[232:233], v26 offset:1440
  ds_read_b64_tr_b16 v[234:235], v26 offset:1408
  v_mfma_f32_32x32x16_bf16 v[80:95], v[140:143], v[192:195], v[80:95]
  ds_read_b128 v[172:175], v25 offset:1536
  ds_read_b64_tr_b16 v[236:237], v26 offset:1952
  ds_read_b64_tr_b16 v[238:239], v26 offset:1920
  v_mfma_f32_32x32x16_bf16 v[80:95], v[128:131], v[204:207], v[80:95]
  ds_read_b128 v[176:179], v25 offset:2048
  ds_read_b64_tr_b16 v[240:241], v26 offset:2464
  ds_read_b64_tr_b16 v[242:243], v26 offset:2432
  v_mfma_f32_32x32x16_bf16 v[96:111], v[136:139], v[200:203], v[96:111]
  ds_read_b128 v[180:183], v25 offset:2560
  ds_read_b64_tr_b16 v[244:245], v26 offset:2976
  ds_read_b64_tr_b16 v[246:247], v26 offset:2944
  v_mfma_f32_32x32x16_bf16 v[96:111], v[140:143], v[196:199], v[96:111]
  ds_read_b128 v[184:187], v25 offset:3072
  ds_read_b64_tr_b16 v[248:249], v26 offset:3488
  ds_read_b64_tr_b16 v[250:251], v26 offset:3456
  v_mfma_f32_32x32x16_bf16 v[96:111], v[132:135], v[204:207], v[96:111]
  ds_read_b128 v[188:191], v25 offset:3584
  ds_read_b64_tr_b16 v[252:253], v26 offset:4000
  ds_read_b64_tr_b16 v[254:255], v26 offset:3968
  v_mfma_f32_32x32x16_bf16 v[96:111], v[144:147], v[192:195], v[96:111]
  v_mfma_f32_32x32x16_bf16 v[96:111], v[128:131], v[208:211], v[96:111]
  v_mfma_f32_32x32x16_bf16 v[112:127], v[144:147], v[204:207], v[112:127]
  v_mfma_f32_32x32x16_bf16 v[112:127], v[140:143], v[208:211], v[112:127]
  s_waitcnt lgkmcnt(0)
  v_mfma_f32_32x32x16_bf16 v[64:79], v[160:163], v[224:227], v[64:79]
  v_mfma_f32_32x32x16_bf16 v[80:95], v[168:171], v[228:231], v[80:95]
  v_mfma_f32_32x32x16_bf16 v[80:95], v[164:167], v[232:235], v[80:95]
  s_nop 9
  v_mov_b32_dpp v40, v79 wave_ror:1 row_mask:0xf bank_mask:0xf
  v_add_f32_dpp v35, v75, v78 wave_ror:1 row_mask:0xf bank_mask:0xf
  v_add_f32_dpp v34, v71, v74 wave_ror:1 row_mask:0xf bank_mask:0xf
  v_add_f32_dpp v33, v67, v70 wave_ror:1 row_mask:0xf bank_mask:0xf
  v_add_f32_dpp v32, v67, v66 wave_shr:1 row_mask:0xf bank_mask:0xf bound_ctrl:0
  v_mfma_f32_32x32x16_bf16 v[80:95], v[172:175], v[224:227], v[80:95]
  v_mov_b32_dpp v40, v60 wave_shr:1 row_mask:0xf bank_mask:0xf
  v_add_f32_dpp v35, v79, v78 wave_shr:1 row_mask:0xf bank_mask:0xf
  v_add_f32_dpp v34, v75, v74 wave_shr:1 row_mask:0xf bank_mask:0xf
  v_add_f32_dpp v33, v71, v70 wave_shr:1 row_mask:0xf bank_mask:0xf
  v_mov_b32_dpp v41, v35 wave_ror:1 row_mask:0xf bank_mask:0xf
  v_mfma_f32_32x32x16_bf16 v[80:95], v[160:163], v[236:239], v[80:95]
  v_add_f32_dpp v79, v34, v77 wave_ror:1 row_mask:0xf bank_mask:0xf
  v_add_f32_dpp v75, v33, v73 wave_ror:1 row_mask:0xf bank_mask:0xf
  v_add_f32_dpp v71, v32, v69 wave_ror:1 row_mask:0xf bank_mask:0xf
  v_add_f32_dpp v67, v32, v65 wave_shr:1 row_mask:0xf bank_mask:0xf bound_ctrl:0
  v_mov_b32_dpp v41, v40 wave_shr:1 row_mask:0xf bank_mask:0xf
  v_mfma_f32_32x32x16_bf16 v[96:111], v[168:171], v[232:235], v[96:111]
  v_add_f32_dpp v79, v35, v77 wave_shr:1 row_mask:0xf bank_mask:0xf
  v_add_f32_dpp v75, v34, v73 wave_shr:1 row_mask:0xf bank_mask:0xf
  v_add_f32_dpp v71, v33, v69 wave_shr:1 row_mask:0xf bank_mask:0xf
  v_mov_b32_dpp v62, v79 wave_ror:1 row_mask:0xf bank_mask:0xf
  v_add_f32_dpp v78, v75, v76 wave_ror:1 row_mask:0xf bank_mask:0xf
  v_mfma_f32_32x32x16_bf16 v[96:111], v[172:175], v[228:231], v[96:111]
  v_add_f32_dpp v74, v71, v72 wave_ror:1 row_mask:0xf bank_mask:0xf
  v_add_f32_dpp v70, v67, v68 wave_ror:1 row_mask:0xf bank_mask:0xf
  v_add_f32_dpp v66, v67, v64 wave_shr:1 row_mask:0xf bank_mask:0xf bound_ctrl:0
  v_mov_b32_dpp v62, v41 wave_shr:1 row_mask:0xf bank_mask:0xf
  v_add_f32_dpp v78, v79, v76 wave_shr:1 row_mask:0xf bank_mask:0xf
  v_mfma_f32_32x32x16_bf16 v[96:111], v[164:167], v[236:239], v[96:111]
  v_add_f32_dpp v74, v75, v72 wave_shr:1 row_mask:0xf bank_mask:0xf
  v_add_f32_dpp v70, v71, v68 wave_shr:1 row_mask:0xf bank_mask:0xf
  v_cvt_pk_bf16_f32 v64, v66, v70
  v_cvt_pk_bf16_f32 v65, v74, v78
  v_mfma_f32_32x32x16_bf16 v[96:111], v[176:179], v[224:227], v[96:111]
  v_mov_b32_dpp v42, v95 wave_ror:1 row_mask:0xf bank_mask:0xf
  v_add_f32_dpp v35, v91, v94 wave_ror:1 row_mask:0xf bank_mask:0xf
  v_add_f32_dpp v34, v87, v90 wave_ror:1 row_mask:0xf bank_mask:0xf
  v_add_f32_dpp v33, v83, v86 wave_ror:1 row_mask:0xf bank_mask:0xf
  v_mfma_f32_32x32x16_bf16 v[96:111], v[160:163], v[240:243], v[96:111]
  v_add_f32_dpp v32, v83, v82 wave_shr:1 row_mask:0xf bank_mask:0xf bound_ctrl:0
  v_mov_b32_dpp v42, v60 wave_shr:1 row_mask:0xf bank_mask:0xf
  v_add_f32_dpp v35, v95, v94 wave_shr:1 row_mask:0xf bank_mask:0xf
  v_add_f32_dpp v34, v91, v90 wave_shr:1 row_mask:0xf bank_mask:0xf
  v_add_f32_dpp v33, v87, v86 wave_shr:1 row_mask:0xf bank_mask:0xf
  v_mfma_f32_32x32x16_bf16 v[112:127], v[148:151], v[200:203], v[112:127]
  v_mov_b32_dpp v43, v35 wave_ror:1 row_mask:0xf bank_mask:0xf
  v_add_f32_dpp v95, v34, v93 wave_ror:1 row_mask:0xf bank_mask:0xf
  v_add_f32_dpp v91, v33, v89 wave_ror:1 row_mask:0xf bank_mask:0xf
  v_add_f32_dpp v87, v32, v85 wave_ror:1 row_mask:0xf bank_mask:0xf
  v_add_f32_dpp v83, v32, v81 wave_shr:1 row_mask:0xf bank_mask:0xf bound_ctrl:0
  v_mfma_f32_32x32x16_bf16 v[112:127], v[136:139], v[212:215], v[112:127]
  v_mov_b32_dpp v43, v42 wave_shr:1 row_mask:0xf bank_mask:0xf
  v_add_f32_dpp v95, v35, v93 wave_shr:1 row_mask:0xf bank_mask:0xf
  v_add_f32_dpp v91, v34, v89 wave_shr:1 row_mask:0xf bank_mask:0xf
  v_add_f32_dpp v87, v33, v85 wave_shr:1 row_mask:0xf bank_mask:0xf
  v_mov_b32_dpp v42, v95 wave_ror:1 row_mask:0xf bank_mask:0xf
  v_mfma_f32_32x32x16_bf16 v[112:127], v[152:155], v[196:199], v[112:127]
  v_add_f32_dpp v94, v91, v92 wave_ror:1 row_mask:0xf bank_mask:0xf
  v_add_f32_dpp v90, v87, v88 wave_ror:1 row_mask:0xf bank_mask:0xf
  v_add_f32_dpp v86, v83, v84 wave_ror:1 row_mask:0xf bank_mask:0xf
  v_add_f32_dpp v82, v83, v80 wave_shr:1 row_mask:0xf bank_mask:0xf bound_ctrl:0
  v_mov_b32_dpp v42, v43 wave_shr:1 row_mask:0xf bank_mask:0xf
  v_mfma_f32_32x32x16_bf16 v[112:127], v[132:135], v[216:219], v[112:127]
  v_add_f32_dpp v94, v95, v92 wave_shr:1 row_mask:0xf bank_mask:0xf
  v_add_f32_dpp v90, v91, v88 wave_shr:1 row_mask:0xf bank_mask:0xf
  v_add_f32_dpp v86, v87, v84 wave_shr:1 row_mask:0xf bank_mask:0xf
  v_mov_b32_dpp v44, v111 wave_ror:1 row_mask:0xf bank_mask:0xf
  v_add_f32_dpp v35, v107, v110 wave_ror:1 row_mask:0xf bank_mask:0xf
  v_mfma_f32_32x32x16_bf16 v[112:127], v[156:159], v[192:195], v[112:127]
  v_add_f32_dpp v34, v103, v106 wave_ror:1 row_mask:0xf bank_mask:0xf
  v_add_f32_dpp v33, v99, v102 wave_ror:1 row_mask:0xf bank_mask:0xf
  v_add_f32_dpp v32, v99, v98 wave_shr:1 row_mask:0xf bank_mask:0xf bound_ctrl:0
  v_mov_b32_dpp v44, v60 wave_shr:1 row_mask:0xf bank_mask:0xf
  v_add_f32_dpp v35, v111, v110 wave_shr:1 row_mask:0xf bank_mask:0xf
  v_mfma_f32_32x32x16_bf16 v[112:127], v[128:131], v[220:223], v[112:127]
  v_add_f32_dpp v34, v107, v106 wave_shr:1 row_mask:0xf bank_mask:0xf
  v_add_f32_dpp v33, v103, v102 wave_shr:1 row_mask:0xf bank_mask:0xf
  v_mov_b32_dpp v45, v35 wave_ror:1 row_mask:0xf bank_mask:0xf
  v_add_f32_dpp v111, v34, v109 wave_ror:1 row_mask:0xf bank_mask:0xf
  v_add_f32_dpp v107, v33, v105 wave_ror:1 row_mask:0xf bank_mask:0xf
  v_mfma_f32_32x32x16_bf16 v[112:127], v[176:179], v[236:239], v[112:127]
  v_add_f32_dpp v103, v32, v101 wave_ror:1 row_mask:0xf bank_mask:0xf
  v_add_f32_dpp v99, v32, v97 wave_shr:1 row_mask:0xf bank_mask:0xf bound_ctrl:0
  v_mov_b32_dpp v45, v44 wave_shr:1 row_mask:0xf bank_mask:0xf
  v_add_f32_dpp v111, v35, v109 wave_shr:1 row_mask:0xf bank_mask:0xf
  v_add_f32_dpp v107, v34, v105 wave_shr:1 row_mask:0xf bank_mask:0xf
  v_mfma_f32_32x32x16_bf16 v[112:127], v[172:175], v[240:243], v[112:127]
  v_add_f32_dpp v103, v33, v101 wave_shr:1 row_mask:0xf bank_mask:0xf
  v_mov_b32_dpp v63, v111 wave_ror:1 row_mask:0xf bank_mask:0xf
  v_add_f32_dpp v110, v107, v108 wave_ror:1 row_mask:0xf bank_mask:0xf
  v_add_f32_dpp v106, v103, v104 wave_ror:1 row_mask:0xf bank_mask:0xf
  v_add_f32_dpp v102, v99, v100 wave_ror:1 row_mask:0xf bank_mask:0xf
  v_mfma_f32_32x32x16_bf16 v[112:127], v[180:183], v[232:235], v[112:127]
  v_add_f32_dpp v98, v99, v96 wave_shr:1 row_mask:0xf bank_mask:0xf bound_ctrl:0
  v_mov_b32_dpp v63, v45 wave_shr:1 row_mask:0xf bank_mask:0xf
  v_add_f32_dpp v110, v111, v108 wave_shr:1 row_mask:0xf bank_mask:0xf
  v_add_f32_dpp v106, v107, v104 wave_shr:1 row_mask:0xf bank_mask:0xf
  v_add_f32_dpp v102, v103, v100 wave_shr:1 row_mask:0xf bank_mask:0xf
  v_mfma_f32_32x32x16_bf16 v[112:127], v[168:171], v[244:247], v[112:127]
  v_add_f32 v98, v42, v98
  s_mov_b64 exec, 8
  v_mov_b32 v62, 1.0
  s_mov_b64 exec, 15
  ds_write_b64 v19, v[62:63]
  s_mov_b64 exec, -1
  v_cvt_pk_bf16_f32 v96, v98, v102
  v_cvt_pk_bf16_f32 v97, v106, v110
  v_mfma_f32_32x32x16_bf16 v[112:127], v[184:187], v[228:231], v[112:127]
  v_mfma_f32_32x32x16_bf16 v[112:127], v[164:167], v[248:251], v[112:127]
  v_mfma_f32_32x32x16_bf16 v[112:127], v[188:191], v[224:227], v[112:127]
  v_mfma_f32_32x32x16_bf16 v[112:127], v[160:163], v[252:255], v[112:127]
  s_setprio 3
  s_nop 10
  v_add_f32_dpp v35, v123, v126 wave_ror:1 row_mask:0xf bank_mask:0xf
  v_add_f32_dpp v34, v119, v122 wave_ror:1 row_mask:0xf bank_mask:0xf
  v_add_f32_dpp v33, v115, v118 wave_ror:1 row_mask:0xf bank_mask:0xf
  v_add_f32_dpp v32, v115, v114 wave_shr:1 row_mask:0xf bank_mask:0xf bound_ctrl:0
  v_add_f32_dpp v35, v127, v126 wave_shr:1 row_mask:0xf bank_mask:0xf
  v_add_f32_dpp v34, v123, v122 wave_shr:1 row_mask:0xf bank_mask:0xf
  v_add_f32_dpp v33, v119, v118 wave_shr:1 row_mask:0xf bank_mask:0xf
  s_nop 0
  v_add_f32_dpp v127, v34, v125 wave_ror:1 row_mask:0xf bank_mask:0xf
  v_add_f32_dpp v123, v33, v121 wave_ror:1 row_mask:0xf bank_mask:0xf
  v_add_f32_dpp v119, v32, v117 wave_ror:1 row_mask:0xf bank_mask:0xf
  v_add_f32_dpp v115, v32, v113 wave_shr:1 row_mask:0xf bank_mask:0xf bound_ctrl:0
  v_add_f32_dpp v127, v35, v125 wave_shr:1 row_mask:0xf bank_mask:0xf
  v_add_f32_dpp v123, v34, v121 wave_shr:1 row_mask:0xf bank_mask:0xf
  v_add_f32_dpp v119, v33, v117 wave_shr:1 row_mask:0xf bank_mask:0xf
  s_nop 0
  v_add_f32_dpp v126, v123, v124 wave_ror:1 row_mask:0xf bank_mask:0xf
  v_add_f32_dpp v122, v119, v120 wave_ror:1 row_mask:0xf bank_mask:0xf
  v_add_f32_dpp v118, v115, v116 wave_ror:1 row_mask:0xf bank_mask:0xf
  v_add_f32_dpp v114, v115, v112 wave_shr:1 row_mask:0xf bank_mask:0xf bound_ctrl:0
  v_add_f32_dpp v126, v127, v124 wave_shr:1 row_mask:0xf bank_mask:0xf
  v_add_f32_dpp v122, v123, v120 wave_shr:1 row_mask:0xf bank_mask:0xf
  v_add_f32_dpp v118, v119, v116 wave_shr:1 row_mask:0xf bank_mask:0xf
  s_add_u32 s12, s10, 3145728
  buffer_store_dwordx2 v[64:65], v59, s[68:71], s12 offen sc1
  s_add_u32 s12, s10, 4063232
  buffer_store_dwordx2 v[96:97], v59, s[68:71], s12 offen sc1
  s_mov_b32 s13, 1048576
L_spin_20:
  ds_read_b64 v[62:63], v61
  s_waitcnt lgkmcnt(0)
  v_readlane_b32 s9, v62, 3
  s_nop 1
  s_cmp_lg_u32 s9, 0
  s_cbranch_scc1 L_spinend_21
  s_sub_u32 s13, s13, 1
  s_cbranch_scc0 L_spin_20
L_spinend_21:
  s_mov_b64 exec, 7
  v_add_f32 v82, v62, v82
  v_add_f32 v114, v63, v114
  s_mov_b64 exec, -1
  v_cvt_pk_bf16_f32 v80, v82, v86
  v_cvt_pk_bf16_f32 v81, v90, v94
  s_add_u32 s12, s10, 3833856
  buffer_store_dwordx2 v[80:81], v59, s[68:71], s12 offen sc1
  v_cvt_pk_bf16_f32 v112, v114, v118
  v_cvt_pk_bf16_f32 v113, v122, v126
  s_add_u32 s12, s10, 4751360
  buffer_store_dwordx2 v[112:113], v59, s[68:71], s12 offen sc1
  s_branch L_convdone
L_conv1:
  ds_read_b128 v[128:131], v25 offset:384
  ds_read_b64_tr_b16 v[192:193], v26 offset:32
  ds_read_b64_tr_b16 v[194:195], v26 offset:0
  ds_read_b128 v[132:135], v25 offset:896
  ds_read_b64_tr_b16 v[196:197], v26 offset:544
  ds_read_b64_tr_b16 v[198:199], v26 offset:512
  ds_read_b128 v[136:139], v25 offset:1408
  ds_read_b64_tr_b16 v[200:201], v26 offset:1056
  ds_read_b64_tr_b16 v[202:203], v26 offset:1024
  ds_read_b128 v[140:143], v25 offset:1920
  ds_read_b64_tr_b16 v[204:205], v26 offset:1568
  ds_read_b64_tr_b16 v[206:207], v26 offset:1536
  ds_read_b128 v[144:147], v25 offset:2432
  ds_read_b64_tr_b16 v[208:209], v26 offset:2080
  ds_read_b64_tr_b16 v[210:211], v26 offset:2048
  ds_read_b128 v[148:151], v25 offset:2944
  ds_read_b64_tr_b16 v[212:213], v26 offset:2592
  ds_read_b64_tr_b16 v[214:215], v26 offset:2560
  ds_read_b128 v[152:155], v25 offset:3456
  ds_read_b64_tr_b16 v[216:217], v26 offset:3104
  ds_read_b64_tr_b16 v[218:219], v26 offset:3072
  s_setprio 3
  s_add_u32 m0, s15, 98304
  s_bfe_u32 s78, s82, 0x40018
  s_mul_i32 s78, s78, 114688
  buffer_load_dwordx4 v9, s[64:67], s78 offen lds
  s_add_u32 m0, s15, 99328
  s_add_u32 s78, s78, 7168
  buffer_load_dwordx4 v9, s[64:67], s78 offen lds
  s_add_u32 m0, s15, 100352
  s_add_u32 s78, s78, 7168
  buffer_load_dwordx4 v9, s[64:67], s78 offen lds
  s_add_u32 m0, s15, 101376
  s_add_u32 s78, s78, 7168
  buffer_load_dwordx4 v9, s[64:67], s78 offen lds
  s_setprio 3
  s_waitcnt lgkmcnt(0)
  v_mfma_f32_32x32x16_bf16 v[64:79], v[132:135], v[192:195], 0
  ds_read_b128 v[160:163], v25 offset:256
  ds_read_b64_tr_b16 v[224:225], v26 offset:160
  v_mfma_f32_32x32x16_bf16 v[64:79], v[128:131], v[196:199], v[64:79]
  ds_read_b64_tr_b16 v[226:227], v26 offset:128
  ds_read_b128 v[164:167], v25 offset:768
  v_mfma_f32_32x32x16_bf16 v[80:95], v[132:135], v[196:199], 0
  ds_read_b64_tr_b16 v[228:229], v26 offset:672
  ds_read_b64_tr_b16 v[230:231], v26 offset:640
  v_mfma_f32_32x32x16_bf16 v[80:95], v[136:139], v[192:195], v[80:95]
  ds_read_b128 v[168:171], v25 offset:1280
  ds_read_b64_tr_b16 v[232:233], v26 offset:1184
  v_mfma_f32_32x32x16_bf16 v[80:95], v[128:131], v[200:203], v[80:95]
  ds_read_b64_tr_b16 v[234:235], v26 offset:1152
  ds_read_b128 v[172:175], v25 offset:1792
  v_mfma_f32_32x32x16_bf16 v[96:111], v[140:143], v[200:203], 0
  ds_read_b64_tr_b16 v[236:237], v26 offset:1696
  ds_read_b64_tr_b16 v[238:239], v26 offset:1664
  v_mfma_f32_32x32x16_bf16 v[96:111], v[136:139], v[204:207], v[96:111]
  ds_read_b128 v[176:179], v25 offset:2304
  ds_read_b64_tr_b16 v[240:241], v26 offset:2208
  v_mfma_f32_32x32x16_bf16 v[112:127], v[140:143], v[204:207], 0
  ds_read_b64_tr_b16 v[242:243], v26 offset:2176
  ds_read_b128 v[180:183], v25 offset:2816
  v_mfma_f32_32x32x16_bf16 v[96:111], v[144:147], v[196:199], v[96:111]
  ds_read_b64_tr_b16 v[244:245], v26 offset:2720
  ds_read_b64_tr_b16 v[246:247], v26 offset:2688
  v_mfma_f32_32x32x16_bf16 v[96:111], v[132:135], v[208:211], v[96:111]
  ds_read_b128 v[184:187], v25 offset:3328
  ds_read_b64_tr_b16 v[248:249], v26 offset:3232
  v_mfma_f32_32x32x16_bf16 v[112:127], v[144:147], v[200:203], v[112:127]
  ds_read_b64_tr_b16 v[250:251], v26 offset:3200
  v_mfma_f32_32x32x16_bf16 v[112:127], v[136:139], v[208:211], v[112:127]
  v_mfma_f32_32x32x16_bf16 v[96:111], v[148:151], v[192:195], v[96:111]
  v_mfma_f32_32x32x16_bf16 v[96:111], v[128:131], v[212:215], v[96:111]
  v_mfma_f32_32x32x16_bf16 v[112:127], v[148:151], v[196:199], v[112:127]
  v_mfma_f32_32x32x16_bf16 v[112:127], v[132:135], v[212:215], v[112:127]
  v_mfma_f32_32x32x16_bf16 v[112:127], v[152:155], v[192:195], v[112:127]
  v_mfma_f32_32x32x16_bf16 v[112:127], v[128:131], v[216:219], v[112:127]
  s_waitcnt lgkmcnt(0)
  s_waitcnt vmcnt(0)
  s_mov_b64 exec, 1
  ds_add_u32 v13, v14 offset:4
  s_mov_b64 exec, -1
  v_mfma_f32_32x32x16_bf16 v[64:79], v[164:167], v[224:227], v[64:79]
  ds_read_b128 v[128:131], v25 offset:128
  ds_read_b64_tr_b16 v[192:193], v26 offset:288
  v_mfma_f32_32x32x16_bf16 v[64:79], v[160:163], v[228:231], v[64:79]
  ds_read_b64_tr_b16 v[194:195], v26 offset:256
  ds_read_b128 v[132:135], v25 offset:640
  v_mfma_f32_32x32x16_bf16 v[80:95], v[164:167], v[228:231], v[80:95]
  ds_read_b64_tr_b16 v[196:197], v26 offset:800
  ds_read_b64_tr_b16 v[198:199], v26 offset:768
  v_mfma_f32_32x32x16_bf16 v[80:95], v[168:171], v[224:227], v[80:95]
  ds_read_b128 v[136:139], v25 offset:1152
  ds_read_b64_tr_b16 v[200:201], v26 offset:1312
  v_mfma_f32_32x32x16_bf16 v[80:95], v[160:163], v[232:235], v[80:95]
  ds_read_b64_tr_b16 v[202:203], v26 offset:1280
  ds_read_b128 v[140:143], v25 offset:1664
  v_mfma_f32_32x32x16_bf16 v[96:111], v[172:175], v[232:235], v[96:111]
  ds_read_b64_tr_b16 v[204:205], v26 offset:1824
  ds_read_b64_tr_b16 v[206:207], v26 offset:1792
  v_mfma_f32_32x32x16_bf16 v[96:111], v[168:171], v[236:239], v[96:111]
  ds_read_b128 v[144:147], v25 offset:2176
  ds_read_b64_tr_b16 v[208:209], v26 offset:2336
  v_mfma_f32_32x32x16_bf16 v[112:127], v[172:175], v[236:239], v[112:127]
  ds_read_b64_tr_b16 v[210:211], v26 offset:2304
  ds_read_b128 v[148:151], v25 offset:2688
  v_mfma_f32_32x32x16_bf16 v[96:111], v[176:179], v[228:231], v[96:111]
  ds_read_b64_tr_b16 v[212:213], v26 offset:2848
  ds_read_b64_tr_b16 v[214:215], v26 offset:2816
  v_mfma_f32_32x32x16_bf16 v[96:111], v[164:167], v[240:243], v[96:111]
  ds_read_b128 v[152:155], v25 offset:3200
  ds_read_b64_tr_b16 v[216:217], v26 offset:3360
  v_mfma_f32_32x32x16_bf16 v[112:127], v[176:179], v[232:235], v[112:127]
  ds_read_b64_tr_b16 v[218:219], v26 offset:3328
  v_mfma_f32_32x32x16_bf16 v[112:127], v[168:171], v[240:243], v[112:127]
  v_mfma_f32_32x32x16_bf16 v[96:111], v[180:183], v[224:227], v[96:111]
  v_mfma_f32_32x32x16_bf16 v[96:111], v[160:163], v[244:247], v[96:111]
  v_mfma_f32_32x32x16_bf16 v[112:127], v[180:183], v[228:231], v[112:127]
  v_mfma_f32_32x32x16_bf16 v[112:127], v[164:167], v[244:247], v[112:127]
  v_mfma_f32_32x32x16_bf16 v[112:127], v[184:187], v[224:227], v[112:127]
  v_mfma_f32_32x32x16_bf16 v[112:127], v[160:163], v[248:251], v[112:127]
  s_lshl1_add_u32 s10, s86, s88
  s_lshl_b32 s10, s10, 9
  v_lshlrev_b32 v59, 3, v0
  v_xor_b32 v61, 64, v19
  s_waitcnt lgkmcnt(0)
  v_mfma_f32_32x32x16_bf16 v[64:79], v[132:135], v[192:195], v[64:79]
  ds_read_b128 v[160:163], v25 offset:0
  ds_read_b64_tr_b16 v[224:225], v26 offset:416
  ds_read_b64_tr_b16 v[226:227], v26 offset:384
  v_mfma_f32_32x32x16_bf16 v[64:79], v[128:131], v[196:199], v[64:79]
  ds_read_b128 v[164:167], v25 offset:512
  ds_read_b64_tr_b16 v[228:229], v26 offset:928
  ds_read_b64_tr_b16 v[230:231], v26 offset:896
  v_mfma_f32_32x32x16_bf16 v[80:95], v[132:135], v[196:199], v[80:95]
  ds_read_b128 v[168:171], v25 offset:1024
  ds_read_b64_tr_b16 v[232:233], v26 offset:1440
  ds_read_b64_tr_b16 v[234:235], v26 offset:1408
  v_mfma_f32_32x32x16_bf16 v[80:95], v[136:139], v[192:195], v[80:95]
  ds_read_b128 v[172:175], v25 offset:1536
  ds_read_b64_tr_b16 v[236:237], v26 offset:1952
  ds_read_b64_tr_b16 v[238:239], v26 offset:1920
  v_mfma_f32_32x32x16_bf16 v[80:95], v[128:131], v[200:203], v[80:95]
  ds_read_b128 v[176:179], v25 offset:2048
  ds_read_b64_tr_b16 v[240:241], v26 offset:2464
  ds_read_b64_tr_b16 v[242:243], v26 offset:2432
  v_mfma_f32_32x32x16_bf16 v[96:111], v[140:143], v[200:203], v[96:111]
  ds_read_b128 v[180:183], v25 offset:2560
  ds_read_b64_tr_b16 v[244:245], v26 offset:2976
  ds_read_b64_tr_b16 v[246:247], v26 offset:2944
  v_mfma_f32_32x32x16_bf16 v[96:111], v[136:139], v[204:207], v[96:111]
  ds_read_b128 v[184:187], v25 offset:3072
  ds_read_b64_tr_b16 v[248:249], v26 offset:3488
  ds_read_b64_tr_b16 v[250:251], v26 offset:3456
  v_mfma_f32_32x32x16_bf16 v[96:111], v[144:147], v[196:199], v[96:111]
  v_mfma_f32_32x32x16_bf16 v[96:111], v[132:135], v[208:211], v[96:111]
  v_mfma_f32_32x32x16_bf16 v[96:111], v[148:151], v[192:195], v[96:111]
  v_mfma_f32_32x32x16_bf16 v[96:111], v[128:131], v[212:215], v[96:111]
  v_mfma_f32_32x32x16_bf16 v[112:127], v[140:143], v[204:207], v[112:127]
  v_mfma_f32_32x32x16_bf16 v[112:127], v[144:147], v[200:203], v[112:127]
  s_waitcnt lgkmcnt(0)
  v_mfma_f32_32x32x16_bf16 v[64:79], v[164:167], v[224:227], v[64:79]
  v_mfma_f32_32x32x16_bf16 v[64:79], v[160:163], v[228:231], v[64:79]
  v_mfma_f32_32x32x16_bf16 v[80:95], v[164:167], v[228:231], v[80:95]
  v_mfma_f32_32x32x16_bf16 v[80:95], v[168:171], v[224:227], v[80:95]
  s_nop 9
  v_mov_b32_dpp v40, v79 wave_ror:1 row_mask:0xf bank_mask:0xf
  v_add_f32_dpp v35, v75, v78 wave_ror:1 row_mask:0xf bank_mask:0xf
  v_add_f32_dpp v34, v71, v74 wave_ror:1 row_mask:0xf bank_mask:0xf
  v_add_f32_dpp v33, v67, v70 wave_ror:1 row_mask:0xf bank_mask:0xf
  v_add_f32_dpp v32, v67, v66 wave_shr:1 row_mask:0xf bank_mask:0xf bound_ctrl:0
  v_mfma_f32_32x32x16_bf16 v[80:95], v[160:163], v[232:235], v[80:95]
  v_mov_b32_dpp v40, v60 wave_shr:1 row_mask:0xf bank_mask:0xf
  v_add_f32_dpp v35, v79, v78 wave_shr:1 row_mask:0xf bank_mask:0xf
  v_add_f32_dpp v34, v75, v74 wave_shr:1 row_mask:0xf bank_mask:0xf
  v_add_f32_dpp v33, v71, v70 wave_shr:1 row_mask:0xf bank_mask:0xf
  v_mov_b32_dpp v41, v35 wave_ror:1 row_mask:0xf bank_mask:0xf
  v_mfma_f32_32x32x16_bf16 v[96:111], v[172:175], v[232:235], v[96:111]
  v_add_f32_dpp v79, v34, v77 wave_ror:1 row_mask:0xf bank_mask:0xf
  v_add_f32_dpp v75, v33, v73 wave_ror:1 row_mask:0xf bank_mask:0xf
  v_add_f32_dpp v71, v32, v69 wave_ror:1 row_mask:0xf bank_mask:0xf
  v_add_f32_dpp v67, v32, v65 wave_shr:1 row_mask:0xf bank_mask:0xf bound_ctrl:0
  v_mov_b32_dpp v41, v40 wave_shr:1 row_mask:0xf bank_mask:0xf
  v_mfma_f32_32x32x16_bf16 v[96:111], v[168:171], v[236:239], v[96:111]
  v_add_f32_dpp v79, v35, v77 wave_shr:1 row_mask:0xf bank_mask:0xf
  v_add_f32_dpp v75, v34, v73 wave_shr:1 row_mask:0xf bank_mask:0xf
  v_add_f32_dpp v71, v33, v69 wave_shr:1 row_mask:0xf bank_mask:0xf
  v_mov_b32_dpp v40, v79 wave_ror:1 row_mask:0xf bank_mask:0xf
  v_add_f32_dpp v78, v75, v76 wave_ror:1 row_mask:0xf bank_mask:0xf
  v_mfma_f32_32x32x16_bf16 v[96:111], v[176:179], v[228:231], v[96:111]
  v_add_f32_dpp v74, v71, v72 wave_ror:1 row_mask:0xf bank_mask:0xf
  v_add_f32_dpp v70, v67, v68 wave_ror:1 row_mask:0xf bank_mask:0xf
  v_add_f32_dpp v66, v67, v64 wave_shr:1 row_mask:0xf bank_mask:0xf bound_ctrl:0
  v_mov_b32_dpp v40, v41 wave_shr:1 row_mask:0xf bank_mask:0xf
  v_add_f32_dpp v78, v79, v76 wave_shr:1 row_mask:0xf bank_mask:0xf
  v_mfma_f32_32x32x16_bf16 v[96:111], v[164:167], v[240:243], v[96:111]
  v_add_f32_dpp v74, v75, v72 wave_shr:1 row_mask:0xf bank_mask:0xf
  v_add_f32_dpp v70, v71, v68 wave_shr:1 row_mask:0xf bank_mask:0xf
  v_mov_b32_dpp v42, v95 wave_ror:1 row_mask:0xf bank_mask:0xf
  v_add_f32_dpp v35, v91, v94 wave_ror:1 row_mask:0xf bank_mask:0xf
  v_add_f32_dpp v34, v87, v90 wave_ror:1 row_mask:0xf bank_mask:0xf
  v_mfma_f32_32x32x16_bf16 v[96:111], v[180:183], v[224:227], v[96:111]
  v_add_f32_dpp v33, v83, v86 wave_ror:1 row_mask:0xf bank_mask:0xf
  v_add_f32_dpp v32, v83, v82 wave_shr:1 row_mask:0xf bank_mask:0xf bound_ctrl:0
  v_mov_b32_dpp v42, v60 wave_shr:1 row_mask:0xf bank_mask:0xf
  v_add_f32_dpp v35, v95, v94 wave_shr:1 row_mask:0xf bank_mask:0xf
  v_add_f32_dpp v34, v91, v90 wave_shr:1 row_mask:0xf bank_mask:0xf
  v_mfma_f32_32x32x16_bf16 v[96:111], v[160:163], v[244:247], v[96:111]
  v_add_f32_dpp v33, v87, v86 wave_shr:1 row_mask:0xf bank_mask:0xf
  v_mov_b32_dpp v43, v35 wave_ror:1 row_mask:0xf bank_mask:0xf
  v_add_f32_dpp v95, v34, v93 wave_ror:1 row_mask:0xf bank_mask:0xf
  v_add_f32_dpp v91, v33, v89 wave_ror:1 row_mask:0xf bank_mask:0xf
  v_add_f32_dpp v87, v32, v85 wave_ror:1 row_mask:0xf bank_mask:0xf
  v_mfma_f32_32x32x16_bf16 v[112:127], v[136:139], v[208:211], v[112:127]
  v_add_f32_dpp v83, v32, v81 wave_shr:1 row_mask:0xf bank_mask:0xf bound_ctrl:0
  v_mov_b32_dpp v43, v42 wave_shr:1 row_mask:0xf bank_mask:0xf
  v_add_f32_dpp v95, v35, v93 wave_shr:1 row_mask:0xf bank_mask:0xf
  v_add_f32_dpp v91, v34, v89 wave_shr:1 row_mask:0xf bank_mask:0xf
  v_add_f32_dpp v87, v33, v85 wave_shr:1 row_mask:0xf bank_mask:0xf
  v_mfma_f32_32x32x16_bf16 v[112:127], v[148:151], v[196:199], v[112:127]
  v_mov_b32_dpp v62, v95 wave_ror:1 row_mask:0xf bank_mask:0xf
  v_add_f32_dpp v94, v91, v92 wave_ror:1 row_mask:0xf bank_mask:0xf
  v_add_f32_dpp v90, v87, v88 wave_ror:1 row_mask:0xf bank_mask:0xf
  v_add_f32_dpp v86, v83, v84 wave_ror:1 row_mask:0xf bank_mask:0xf
  v_add_f32_dpp v82, v83, v80 wave_shr:1 row_mask:0xf bank_mask:0xf bound_ctrl:0
  v_mfma_f32_32x32x16_bf16 v[112:127], v[132:135], v[212:215], v[112:127]
  v_mov_b32_dpp v62, v43 wave_shr:1 row_mask:0xf bank_mask:0xf
  v_add_f32_dpp v94, v95, v92 wave_shr:1 row_mask:0xf bank_mask:0xf
  v_add_f32_dpp v90, v91, v88 wave_shr:1 row_mask:0xf bank_mask:0xf
  v_add_f32_dpp v86, v87, v84 wave_shr:1 row_mask:0xf bank_mask:0xf
  v_add_f32 v82, v40, v82
  v_mfma_f32_32x32x16_bf16 v[112:127], v[152:155], v[192:195], v[112:127]
  v_cvt_pk_bf16_f32 v80, v82, v86
  v_cvt_pk_bf16_f32 v81, v90, v94
  v_mov_b32_dpp v44, v111 wave_ror:1 row_mask:0xf bank_mask:0xf
  v_mfma_f32_32x32x16_bf16 v[112:127], v[128:131], v[216:219], v[112:127]
  v_add_f32_dpp v35, v107, v110 wave_ror:1 row_mask:0xf bank_mask:0xf
  v_add_f32_dpp v34, v103, v106 wave_ror:1 row_mask:0xf bank_mask:0xf
  v_add_f32_dpp v33, v99, v102 wave_ror:1 row_mask:0xf bank_mask:0xf
  v_add_f32_dpp v32, v99, v98 wave_shr:1 row_mask:0xf bank_mask:0xf bound_ctrl:0
  v_mov_b32_dpp v44, v60 wave_shr:1 row_mask:0xf bank_mask:0xf
  v_mfma_f32_32x32x16_bf16 v[112:127], v[172:175], v[236:239], v[112:127]
  v_add_f32_dpp v35, v111, v110 wave_shr:1 row_mask:0xf bank_mask:0xf
  v_add_f32_dpp v34, v107, v106 wave_shr:1 row_mask:0xf bank_mask:0xf
  v_add_f32_dpp v33, v103, v102 wave_shr:1 row_mask:0xf bank_mask:0xf
  v_mov_b32_dpp v45, v35 wave_ror:1 row_mask:0xf bank_mask:0xf
  v_add_f32_dpp v111, v34, v109 wave_ror:1 row_mask:0xf bank_mask:0xf
  v_mfma_f32_32x32x16_bf16 v[112:127], v[176:179], v[232:235], v[112:127]
  v_add_f32_dpp v107, v33, v105 wave_ror:1 row_mask:0xf bank_mask:0xf
  v_add_f32_dpp v103, v32, v101 wave_ror:1 row_mask:0xf bank_mask:0xf
  v_add_f32_dpp v99, v32, v97 wave_shr:1 row_mask:0xf bank_mask:0xf bound_ctrl:0
  v_mov_b32_dpp v45, v44 wave_shr:1 row_mask:0xf bank_mask:0xf
  v_add_f32_dpp v111, v35, v109 wave_shr:1 row_mask:0xf bank_mask:0xf
  v_mfma_f32_32x32x16_bf16 v[112:127], v[168:171], v[240:243], v[112:127]
  v_add_f32_dpp v107, v34, v105 wave_shr:1 row_mask:0xf bank_mask:0xf
  v_add_f32_dpp v103, v33, v101 wave_shr:1 row_mask:0xf bank_mask:0xf
  v_mov_b32_dpp v44, v111 wave_ror:1 row_mask:0xf bank_mask:0xf
  v_add_f32_dpp v110, v107, v108 wave_ror:1 row_mask:0xf bank_mask:0xf
  v_add_f32_dpp v106, v103, v104 wave_ror:1 row_mask:0xf bank_mask:0xf
  v_mfma_f32_32x32x16_bf16 v[112:127], v[180:183], v[228:231], v[112:127]
  v_add_f32_dpp v102, v99, v100 wave_ror:1 row_mask:0xf bank_mask:0xf
  v_add_f32_dpp v98, v99, v96 wave_shr:1 row_mask:0xf bank_mask:0xf bound_ctrl:0
  v_mov_b32_dpp v44, v45 wave_shr:1 row_mask:0xf bank_mask:0xf
  v_add_f32_dpp v110, v111, v108 wave_shr:1 row_mask:0xf bank_mask:0xf
  v_add_f32_dpp v106, v107, v104 wave_shr:1 row_mask:0xf bank_mask:0xf
  v_mfma_f32_32x32x16_bf16 v[112:127], v[164:167], v[244:247], v[112:127]
  v_add_f32_dpp v102, v103, v100 wave_shr:1 row_mask:0xf bank_mask:0xf
  v_mfma_f32_32x32x16_bf16 v[112:127], v[184:187], v[224:227], v[112:127]
  v_mfma_f32_32x32x16_bf16 v[112:127], v[160:163], v[248:251], v[112:127]
  s_setprio 3
  s_nop 10
  v_mov_b32_dpp v46, v127 wave_ror:1 row_mask:0xf bank_mask:0xf
  v_add_f32_dpp v35, v123, v126 wave_ror:1 row_mask:0xf bank_mask:0xf
  v_add_f32_dpp v34, v119, v122 wave_ror:1 row_mask:0xf bank_mask:0xf
  v_add_f32_dpp v33, v115, v118 wave_ror:1 row_mask:0xf bank_mask:0xf
  v_add_f32_dpp v32, v115, v114 wave_shr:1 row_mask:0xf bank_mask:0xf bound_ctrl:0
  v_mov_b32_dpp v46, v60 wave_shr:1 row_mask:0xf bank_mask:0xf
  v_add_f32_dpp v35, v127, v126 wave_shr:1 row_mask:0xf bank_mask:0xf
  v_add_f32_dpp v34, v123, v122 wave_shr:1 row_mask:0xf bank_mask:0xf
  v_add_f32_dpp v33, v119, v118 wave_shr:1 row_mask:0xf bank_mask:0xf
  v_mov_b32_dpp v47, v35 wave_ror:1 row_mask:0xf bank_mask:0xf
  v_add_f32_dpp v127, v34, v125 wave_ror:1 row_mask:0xf bank_mask:0xf
  v_add_f32_dpp v123, v33, v121 wave_ror:1 row_mask:0xf bank_mask:0xf
  v_add_f32_dpp v119, v32, v117 wave_ror:1 row_mask:0xf bank_mask:0xf
  v_add_f32_dpp v115, v32, v113 wave_shr:1 row_mask:0xf bank_mask:0xf bound_ctrl:0
  v_mov_b32_dpp v47, v46 wave_shr:1 row_mask:0xf bank_mask:0xf
  v_add_f32_dpp v127, v35, v125 wave_shr:1 row_mask:0xf bank_mask:0xf
  v_add_f32_dpp v123, v34, v121 wave_shr:1 row_mask:0xf bank_mask:0xf
  v_add_f32_dpp v119, v33, v117 wave_shr:1 row_mask:0xf bank_mask:0xf
  v_mov_b32_dpp v63, v127 wave_ror:1 row_mask:0xf bank_mask:0xf
  v_add_f32_dpp v126, v123, v124 wave_ror:1 row_mask:0xf bank_mask:0xf
  v_add_f32_dpp v122, v119, v120 wave_ror:1 row_mask:0xf bank_mask:0xf
  v_add_f32_dpp v118, v115, v116 wave_ror:1 row_mask:0xf bank_mask:0xf
  v_add_f32_dpp v114, v115, v112 wave_shr:1 row_mask:0xf bank_mask:0xf bound_ctrl:0
  v_mov_b32_dpp v63, v47 wave_shr:1 row_mask:0xf bank_mask:0xf
  v_add_f32_dpp v126, v127, v124 wave_shr:1 row_mask:0xf bank_mask:0xf
  v_add_f32_dpp v122, v123, v120 wave_shr:1 row_mask:0xf bank_mask:0xf
  v_add_f32_dpp v118, v119, v116 wave_shr:1 row_mask:0xf bank_mask:0xf
  v_add_f32 v114, v44, v114
  s_mov_b64 exec, 8
  v_mov_b32 v62, 1.0
  s_mov_b64 exec, 15
  ds_write_b64 v19, v[62:63]
  s_mov_b64 exec, -1
  v_cvt_pk_bf16_f32 v112, v114, v118
  v_cvt_pk_bf16_f32 v113, v122, v126
  s_add_u32 s12, s10, 3604480
  buffer_store_dwordx2 v[80:81], v59, s[68:71], s12 offen sc1
  s_add_u32 s12, s10, 4521984
  buffer_store_dwordx2 v[112:113], v59, s[68:71], s12 offen sc1
  s_mov_b32 s13, 1048576
L_spin_22:
  ds_read_b64 v[62:63], v61
  s_waitcnt lgkmcnt(0)
  v_readlane_b32 s9, v62, 3
  s_nop 1
  s_cmp_lg_u32 s9, 0
  s_cbranch_scc1 L_spinend_23
  s_sub_u32 s13, s13, 1
  s_cbranch_scc0 L_spin_22
L_spinend_23:
  s_mov_b64 exec, 7
  v_add_f32 v66, v62, v66
  v_add_f32 v98, v63, v98
  s_mov_b64 exec, -1
  v_cvt_pk_bf16_f32 v64, v66, v70
  v_cvt_pk_bf16_f32 v65, v74, v78
  s_add_u32 s12, s10, 3375104
  buffer_store_dwordx2 v[64:65], v59, s[68:71], s12 offen sc1
  v_cvt_pk_bf16_f32 v96, v98, v102
  v_cvt_pk_bf16_f32 v97, v106, v110
  s_add_u32 s12, s10, 4292608
  buffer_store_dwordx2 v[96:97], v59, s[68:71], s12 offen sc1
L_convdone:
  s_lshl3_add_u32 s96, s86, s8
  s_lshl_b32 s96, s96, 5
  s_add_u32 s96, s96, 65536
  v_lshrrev_b32 v47, 4, v0
  v_and_b32 v48, 15, v0
  v_lshlrev_b32 v49, 11, v47
  v_lshl_add_u32 v49, v48, 3, v49
  s_mul_i32 s95, s4, 28
  s_lshl2_add_u32 s95, s7, s95
  s_add_u32 s95, s95, s8
  s_lshl_b32 s95, s95, 6
  s_add_u32 s95, s95, s6
  s_lshl_b32 s95, s95, 7
  s_add_u32 s95, s95, 3145728
  v_lshrrev_b32 v50, 1, v48
  s_lshl_b32 s94, s8, 1
  v_xor_b32 v50, s94, v50
  v_lshl_add_u32 v50, v50, 1, 0
  v_xor_b32 v50, v50, v47
  v_lshlrev_b32 v50, 3, v50
  v_lshl_add_u32 v50, v48, 9, v50
  v_add_u32 v50, 52224, v50
  s_mov_b32 s10, 0x05040100
  s_mov_b32 s12, 0x07060302
  s_lshl2_add_u32 s9, s7, s8
  s_lshl_b32 s9, s9, 11
  s_add_u32 s11, s4, 1
  s_lshl_b32 s11, s11, 4
  s_and_b32 s11, s11, 32
  s_add_u32 s9, s9, s11
  s_add_u32 s9, s9, 65536
  v_lshrrev_b32 v51, 1, v48
  v_lshl_add_u32 v51, v51, 8, s9
  v_and_b32 v52, 1, v48
  v_lshl_add_u32 v51, v52, 6, v51
  s_waitcnt vmcnt(0)
  s_mov_b64 exec, 0xff
  buffer_store_dword v12, v7, s[68:71], s96 offen sc1
  s_mov_b64 exec, -1
  s_setprio 0
  s_mov_b32 s13, 1048576
L_spin_24:
  ds_read_b32 v15, v13 offset:8
  s_waitcnt lgkmcnt(0)
  v_readfirstlane_b32 s9, v15
  s_nop 1
  s_cmp_ge_u32 s9, 4
  s_cbranch_scc1 L_spinend_25
  s_sub_u32 s13, s13, 1
  s_cbranch_scc0 L_spin_24
L_spinend_25:
  s_setprio 3
  s_mov_b32 m0, 51200
  s_nop 0
  buffer_load_dword v27, s[68:71], 0 offen sc1 lds
  s_mov_b32 s13, 131072
L_spin_26:
  buffer_load_dword v52, v51, s[68:71], 0 offen sc1
  s_waitcnt vmcnt(0)
  v_cmp_ne_u32 vcc, s50, v52
  s_cbranch_vccz L_spinend_27
  s_sub_u32 s13, s13, 1
  s_cbranch_scc0 L_spin_26
L_spinend_27:
  buffer_load_dwordx2 v[128:129], v49, s[68:71], s95 offen offset:0 sc1
  buffer_load_dwordx2 v[130:131], v49, s[68:71], s95 offen offset:512 sc1
  buffer_load_dwordx2 v[132:133], v49, s[68:71], s95 offen offset:1024 sc1
  buffer_load_dwordx2 v[134:135], v49, s[68:71], s95 offen offset:1536 sc1
  s_waitcnt vmcnt(0)
  v_perm_b32 v144, v130, v128, s10
  v_perm_b32 v145, v134, v132, s10
  ds_write_b64 v50, v[144:145] offset:0
  v_perm_b32 v146, v130, v128, s12
  v_perm_b32 v147, v134, v132, s12
  ds_write_b64 v50, v[146:147] offset:128
  v_perm_b32 v148, v131, v129, s10
  v_perm_b32 v149, v135, v133, s10
  ds_write_b64 v50, v[148:149] offset:256
  v_perm_b32 v150, v131, v129, s12
  v_perm_b32 v151, v135, v133, s12
  ds_write_b64 v50, v[150:151] offset:384
  s_branch L_final
L_helper:
  s_and_b32 s83, s5, 3
  s_lshr_b32 s9, s4, 1
  s_lshl2_add_u32 s83, s9, s83
  s_and_b32 s9, s4, 1
  s_lshl4_add_u32 s83, s9, s83
  v_mov_b32 v2, 0
  v_lshlrev_b32 v3, 4, v0
  v_lshlrev_b32 v7, 2, v0
  s_lshl3_add_u32 s9, s83, s3
  s_mul_i32 s9, s9, 7168
  s_mul_i32 s10, s3, 7296
  v_and_b32 v5, 7, v0
  v_lshlrev_b32 v5, 4, v5
  s_waitcnt lgkmcnt(0)
  s_mov_b64 s[52:53], s[16:17]
  s_mov_b32 s54, 1835008
  s_mov_b32 s55, 0x20000
  s_mov_b64 s[68:69], s[48:49]
  s_mov_b32 s70, 16777216
  s_mov_b32 s71, 0x20000
  s_mov_b64 s[64:65], s[40:41]
  s_mov_b32 s66, 1605632
  s_mov_b32 s67, 0x20000
  s_or_b32 s12, s83, s3
  s_cmp_lg_u32 s12, 0
  s_cbranch_scc1 L_h_non
  buffer_load_dword v4, v2, s[68:71], 0 offen sc1
  s_waitcnt vmcnt(0)
  s_mov_b32 s84, 1664525
  v_mul_lo_u32 v4, v4, s84
  v_add_u32 v4, 1013904223, v4
  v_max_u32 v4, 1, v4
  global_store_dword v2, v4, s[46:47] sc1
  buffer_store_dword v4, v2, s[68:71], 0 offen sc1
L_h_non:
  v_lshlrev_b32 v17, 7, v0
  s_and_b32 s84, s5, 3
  s_lshl2_add_u32 s84, s3, s84
  s_mul_i32 s85, s4, 12
  s_add_u32 s84, s84, s85
  s_mov_b32 exec_hi, 0x00ffffff
  s_add_u32 m0, s10, 0
  s_nop 0
  buffer_load_dwordx4 v3, s[52:55], s9 offen lds
  s_add_u32 m0, s10, 912
  s_add_u32 s9, s9, 896
  buffer_load_dwordx4 v3, s[52:55], s9 offen lds
  s_add_u32 m0, s10, 1824
  s_add_u32 s9, s9, 896
  buffer_load_dwordx4 v3, s[52:55], s9 offen lds
  s_add_u32 m0, s10, 2736
  s_add_u32 s9, s9, 896
  buffer_load_dwordx4 v3, s[52:55], s9 offen lds
  s_add_u32 m0, s10, 3648
  s_add_u32 s9, s9, 896
  buffer_load_dwordx4 v3, s[52:55], s9 offen lds
  s_add_u32 m0, s10, 4560
  s_add_u32 s9, s9, 896
  buffer_load_dwordx4 v3, s[52:55], s9 offen lds
  s_add_u32 m0, s10, 5472
  s_add_u32 s9, s9, 896
  buffer_load_dwordx4 v3, s[52:55], s9 offen lds
  s_add_u32 m0, s10, 6384
  s_add_u32 s9, s9, 896
  buffer_load_dwordx4 v3, s[52:55], s9 offen lds
  s_mov_b64 s[72:73], s[42:43]
  s_mov_b32 s74, 896
  s_mov_b32 s75, 0x20000
  s_mov_b32 m0, 115712
  s_nop 0
  buffer_load_dwordx4 v3, s[72:75], 0 offen lds
  s_mov_b32 exec_hi, -1
  v_bfe_u32 v8, v0, 2, 2
  v_mul_u32_u24 v8, 3648, v8
  v_lshrrev_b32 v9, 4, v0
  v_lshl_add_u32 v8, v9, 5, v8
  v_and_b32 v9, 3, v0
  v_lshl_add_u32 v8, v9, 3, v8
  s_lshr_b32 s9, s3, 2
  s_mul_i32 s10, s9, 29184
  s_and_b32 s12, s3, 3
  s_mul_i32 s11, s12, 912
  s_add_u32 s10, s10, s11
  v_add_u32 v8, s10, v8
  s_lshl1_add_u32 s9, s12, s9
  v_and_b32 v13, 7, v0
  v_xor_b32 v13, s9, v13
  v_lshlrev_b32 v13, 4, v13
  v_lshl_add_u32 v13, v0, 7, v13
  v_add_u32 v13, 58368, v13
  s_lshl_b32 s10, s3, 10
  s_mul_i32 s9, s83, 57344
  s_add_u32 s9, s9, s10
  s_add_u32 s9, s9, 1048576
  s_add_u32 s10, s10, 58368
  v_add_u32 v14, s10, v3
  v_lshrrev_b32 v9, 3, v0
  s_lshl_b32 s10, s3, 3
  v_add_u32 v9, s10, v9
  v_mul_u32_u24 v10, 912, v9
  v_add_u32 v10, v10, v5
  v_lshlrev_b32 v9, 2, v9
  v_mov_b32 v11, 0
  v_mov_b32 v12, 0
  s_waitcnt vmcnt(0)
  s_barrier
  global_load_dword v4, v2, s[46:47] sc1
  s_add_u32 s85, s84, 0
  s_sub_u32 s86, s85, 98
  s_cselect_b32 s85, s85, s86
  s_mul_i32 s86, s85, 147
  s_lshr_b32 s86, s86, 10
  s_mul_i32 s86, s86, 7
  s_add_u32 s85, s85, s86
  s_add_u32 s85, s85, 0
  s_lshl_b32 s85, s85, 13
  buffer_load_dword v16, v17, s[64:67], s85 offen
  ds_read_b64_tr_b16 v[64:65], v8 offset:0
  ds_read_b64_tr_b16 v[66:67], v8 offset:14592
  ds_read_b64_tr_b16 v[68:69], v8 offset:128
  ds_read_b64_tr_b16 v[70:71], v8 offset:14720
  ds_read_b64_tr_b16 v[72:73], v8 offset:256
  ds_read_b64_tr_b16 v[74:75], v8 offset:14848
  ds_read_b64_tr_b16 v[76:77], v8 offset:384
  ds_read_b64_tr_b16 v[78:79], v8 offset:14976
  ds_read_b64_tr_b16 v[80:81], v8 offset:512
  ds_read_b64_tr_b16 v[82:83], v8 offset:15104
  ds_read_b64_tr_b16 v[84:85], v8 offset:640
  ds_read_b64_tr_b16 v[86:87], v8 offset:15232
  ds_read_b64_tr_b16 v[88:89], v8 offset:768
  ds_read_b64_tr_b16 v[90:91], v8 offset:15360
  s_waitcnt lgkmcnt(12)
  ds_write_b128 v13, v[64:67] offset:0
  s_waitcnt lgkmcnt(11)
  ds_write_b128 v13, v[68:71] offset:8192
  s_waitcnt lgkmcnt(10)
  ds_write_b128 v13, v[72:75] offset:16384
  s_waitcnt lgkmcnt(9)
  ds_write_b128 v13, v[76:79] offset:24576
  s_waitcnt lgkmcnt(8)
  ds_write_b128 v13, v[80:83] offset:32768
  s_waitcnt lgkmcnt(7)
  ds_write_b128 v13, v[84:87] offset:40960
  s_waitcnt lgkmcnt(6)
  ds_write_b128 v13, v[88:91] offset:49152
  ds_read_b128 v[96:99], v10 offset:0
  ds_read_b128 v[100:103], v10 offset:128
  ds_read_b128 v[104:107], v10 offset:256
  ds_read_b128 v[108:111], v10 offset:384
  ds_read_b128 v[112:115], v10 offset:512
  ds_read_b128 v[116:119], v10 offset:640
  ds_read_b128 v[120:123], v10 offset:768
  s_waitcnt lgkmcnt(7)
  s_barrier
  ds_read_b128 v[64:67], v14 offset:0
  ds_read_b128 v[68:71], v14 offset:8192
  ds_read_b128 v[72:75], v14 offset:16384
  ds_read_b128 v[76:79], v14 offset:24576
  ds_read_b128 v[80:83], v14 offset:32768
  ds_read_b128 v[84:87], v14 offset:40960
  ds_read_b128 v[88:91], v14 offset:49152
  s_waitcnt lgkmcnt(6)
  buffer_store_dwordx4 v[64:67], v3, s[68:71], s9 offen sc1
  s_waitcnt lgkmcnt(5)
  s_add_u32 s9, s9, 8192
  buffer_store_dwordx4 v[68:71], v3, s[68:71], s9 offen sc1
  s_waitcnt lgkmcnt(4)
  s_add_u32 s9, s9, 8192
  buffer_store_dwordx4 v[72:75], v3, s[68:71], s9 offen sc1
  s_waitcnt lgkmcnt(3)
  s_add_u32 s9, s9, 8192
  buffer_store_dwordx4 v[76:79], v3, s[68:71], s9 offen sc1
  s_waitcnt lgkmcnt(2)
  s_add_u32 s9, s9, 8192
  buffer_store_dwordx4 v[80:83], v3, s[68:71], s9 offen sc1
  s_waitcnt lgkmcnt(1)
  s_add_u32 s9, s9, 8192
  buffer_store_dwordx4 v[84:87], v3, s[68:71], s9 offen sc1
  s_waitcnt lgkmcnt(0)
  s_add_u32 s9, s9, 8192
  buffer_store_dwordx4 v[88:91], v3, s[68:71], s9 offen sc1
  v_add_u32 v5, 115712, v5
  ds_read_b128 v[32:35], v5 offset:0
  ds_read_b128 v[36:39], v5 offset:128
  ds_read_b128 v[40:43], v5 offset:256
  ds_read_b128 v[44:47], v5 offset:384
  ds_read_b128 v[48:51], v5 offset:512
  ds_read_b128 v[52:55], v5 offset:640
  ds_read_b128 v[56:59], v5 offset:768
  s_waitcnt lgkmcnt(0)
  v_dot2_f32_bf16 v11, v96, v32, v11
  v_dot2_f32_bf16 v12, v97, v33, v12
  v_dot2_f32_bf16 v11, v98, v34, v11
  v_dot2_f32_bf16 v12, v99, v35, v12
  v_dot2_f32_bf16 v11, v100, v36, v11
  v_dot2_f32_bf16 v12, v101, v37, v12
  v_dot2_f32_bf16 v11, v102, v38, v11
  v_dot2_f32_bf16 v12, v103, v39, v12
  v_dot2_f32_bf16 v11, v104, v40, v11
  v_dot2_f32_bf16 v12, v105, v41, v12
  v_dot2_f32_bf16 v11, v106, v42, v11
  v_dot2_f32_bf16 v12, v107, v43, v12
  v_dot2_f32_bf16 v11, v108, v44, v11
  v_dot2_f32_bf16 v12, v109, v45, v12
  v_dot2_f32_bf16 v11, v110, v46, v11
  v_dot2_f32_bf16 v12, v111, v47, v12
  v_dot2_f32_bf16 v11, v112, v48, v11
  v_dot2_f32_bf16 v12, v113, v49, v12
  v_dot2_f32_bf16 v11, v114, v50, v11
  v_dot2_f32_bf16 v12, v115, v51, v12
  v_dot2_f32_bf16 v11, v116, v52, v11
  v_dot2_f32_bf16 v12, v117, v53, v12
  v_dot2_f32_bf16 v11, v118, v54, v11
  v_dot2_f32_bf16 v12, v119, v55, v12
  v_dot2_f32_bf16 v11, v120, v56, v11
  v_dot2_f32_bf16 v12, v121, v57, v12
  v_dot2_f32_bf16 v11, v122, v58, v11
  v_dot2_f32_bf16 v12, v123, v59, v12
  s_nop 2
  v_add_f32 v11, v11, v12
  s_nop 1
  v_add_f32_dpp v11, v11, v11 quad_perm:[1,0,3,2] row_mask:0xf bank_mask:0xf
  s_nop 1
  v_add_f32_dpp v11, v11, v11 quad_perm:[2,3,0,1] row_mask:0xf bank_mask:0xf
  s_nop 1
  v_add_f32_dpp v11, v11, v11 row_half_mirror row_mask:0xf bank_mask:0xf
  v_mul_f32 v11, 0xbfb8aa3b, v11
  v_exp_f32 v11, v11
  s_nop 0
  v_add_f32 v11, 1.0, v11
  v_rcp_f32 v11, v11
  s_lshl_b32 s10, s83, 8
  s_add_u32 s10, s10, 16384
  buffer_store_dword v11, v9, s[68:71], s10 offen sc1
  s_waitcnt vmcnt(0)
  s_barrier
  s_cmp_lg_u32 s3, 0
  s_cbranch_scc1 L_h_end
  v_readfirstlane_b32 s50, v4
  s_nop 1
  s_cmp_lg_u32 s50, 0
  s_cbranch_scc1 L_nonok_28
  s_mov_b32 s13, 131072
L_spin_29:
  global_load_dword v4, v2, s[46:47] sc1
  s_waitcnt vmcnt(0)
  v_readfirstlane_b32 s50, v4
  s_nop 1
  s_cmp_lg_u32 s50, 0
  s_cbranch_scc1 L_spinend_30
  s_sub_u32 s13, s13, 1
  s_cbranch_scc0 L_spin_29
L_spinend_30:
L_nonok_28:
  s_lshl_b32 s10, s83, 8
  s_add_u32 s10, s10, 4096
  buffer_store_dword v4, v7, s[68:71], s10 offen sc1
L_h_end:
  s_barrier
  s_add_u32 s85, s84, 32
  s_sub_u32 s86, s85, 98
  s_cselect_b32 s85, s85, s86
  s_mul_i32 s86, s85, 147
  s_lshr_b32 s86, s86, 10
  s_mul_i32 s86, s86, 7
  s_add_u32 s85, s85, s86
  s_add_u32 s85, s85, 0
  s_lshl_b32 s85, s85, 13
  buffer_load_dword v16, v17, s[64:67], s85 offen
  s_add_u32 s85, s84, 64
  s_sub_u32 s86, s85, 98
  s_cselect_b32 s85, s85, s86
  s_mul_i32 s86, s85, 147
  s_lshr_b32 s86, s86, 10
  s_mul_i32 s86, s86, 7
  s_add_u32 s85, s85, s86
  s_add_u32 s85, s85, 0
  s_lshl_b32 s85, s85, 13
  buffer_load_dword v16, v17, s[64:67], s85 offen
  s_add_u32 s85, s84, 0
  s_sub_u32 s86, s85, 98
  s_cselect_b32 s85, s85, s86
  s_mul_i32 s86, s85, 147
  s_lshr_b32 s86, s86, 10
  s_mul_i32 s86, s86, 7
  s_add_u32 s85, s85, s86
  s_add_u32 s85, s85, 7
  s_lshl_b32 s85, s85, 13
  buffer_load_dword v16, v17, s[64:67], s85 offen
  s_add_u32 s85, s84, 32
  s_sub_u32 s86, s85, 98
  s_cselect_b32 s85, s85, s86
  s_mul_i32 s86, s85, 147
  s_lshr_b32 s86, s86, 10
  s_mul_i32 s86, s86, 7
  s_add_u32 s85, s85, s86
  s_add_u32 s85, s85, 7
  s_lshl_b32 s85, s85, 13
  buffer_load_dword v16, v17, s[64:67], s85 offen
  s_add_u32 s85, s84, 64
  s_sub_u32 s86, s85, 98
  s_cselect_b32 s85, s85, s86
  s_mul_i32 s86, s85, 147
  s_lshr_b32 s86, s86, 10
  s_mul_i32 s86, s86, 7
  s_add_u32 s85, s85, s86
  s_add_u32 s85, s85, 7
  s_lshl_b32 s85, s85, 13
  buffer_load_dword v16, v17, s[64:67], s85 offen
L_h_done:
  s_endpgm
L_codeend:
.section .rodata,"a"
.p2align 6
.amdhsa_kernel gated_mix__ssm_conv_s4__glu_gated_glu__prompt_kernel
  .amdhsa_next_free_vgpr 256
  .amdhsa_next_free_sgpr 102
  .amdhsa_accum_offset 256
  .amdhsa_group_segment_fixed_size 0
  .amdhsa_kernarg_size 136
  .amdhsa_user_sgpr_count 2
  .amdhsa_user_sgpr_kernarg_segment_ptr 1
  .amdhsa_system_sgpr_workgroup_id_x 1
.end_amdhsa_kernel
```
